```python
import torch

def _softmax(x, axis=-1):
    return torch.softmax(x, dim=axis)
def _gelu(x):
    return torch.nn.functional.gelu(x, approximate="tanh")
def _silu(x):
    return torch.nn.functional.silu(x)
def _sigmoid(x):
    return torch.sigmoid(x)
def _layernorm(x, axis=-1, eps=1e-5):
    m = x.mean(dim=axis, keepdim=True)
    v = x.var(dim=axis, keepdim=True, unbiased=False)
    return (x - m) / torch.sqrt(v + eps)
def _scatter_add(tgt, idx, src, axis=0):
    return tgt.clone().index_add_(axis, idx, src)
def _segment_sum(src, seg, n):
    out = torch.zeros((n,) + src.shape[1:], dtype=src.dtype)
    return out.index_add_(0, seg, src)
def _pad(x, pw):
    flat = tuple(v for pair in reversed(pw) for v in pair)
    return torch.nn.functional.pad(x, flat)

kernel_name = 'gated_mix__sliding_block__glu_gated_glu__prompt'

def setup_inputs():

    _w = (lambda a: (lambda t: t.to(torch.bfloat16) if t.is_floating_point() else t)(torch.as_tensor(a)))
    def _A_setup():
        B, S, D = 1, 2048, 512
        return {
            "x": _w((lambda *s: torch.randn(*s, dtype=torch.bfloat16) * 0.05)(B, S, D)),
            "wqkv": _w((lambda *s: torch.randn(*s, dtype=torch.bfloat16) * 0.8)(D, 3 * D)),
            "wo": _w((lambda *s: torch.randn(*s, dtype=torch.bfloat16) * 0.05)(D, D)),
        }
    _A_in = _A_setup()

    def _B_setup():
        B, S, D, F = 1, 2048, 512, 1376
        return {
            "x": _w((lambda *s: torch.randn(*s, dtype=torch.bfloat16) * 0.05)(B, S, D)),
            "w_gate": _w((lambda *s: torch.randn(*s, dtype=torch.bfloat16) * 1.6)(D, F)),
            "w_up": _w((lambda *s: torch.randn(*s, dtype=torch.bfloat16) * 0.1)(D, F)),
            "w_down": _w((lambda *s: torch.randn(*s, dtype=torch.bfloat16) * 0.1)(F, D)),
        }
    _B_in = _B_setup()

    return {
        "A_x": _A_in["x"],
        "A_wqkv": _A_in["wqkv"],
        "A_wo": _A_in["wo"],
        "B_x": _B_in["x"],
        "B_w_gate": _B_in["w_gate"],
        "B_w_up": _B_in["w_up"],
        "B_w_down": _B_in["w_down"],
        "gate_w": _w((lambda *s: torch.randn(*s, dtype=torch.bfloat16) * 0.05)(512) * 16.0),
    }

def reference(A_x, A_wqkv, A_wo, B_x, B_w_gate, B_w_up, B_w_down, gate_w):
    def _A_ref(x, wqkv, wo):
        B, S, D = x.shape
        H = 32; Dh = D // H; W = 256
        qkv = (lambda x, *d: x.permute(*d))((x @ wqkv).reshape(B, S, 3, H, Dh), 2, 0, 3, 1, 4)
        q, k, v = qkv[0], qkv[1], qkv[2]
        scores = torch.einsum("bhqd,bhkd->bhqk", q, k) * (Dh ** -0.5)
        idx = torch.arange(S)
        mask = (idx[:, None] - idx[None, :] >= 0) & (idx[:, None] - idx[None, :] < W)
        scores = torch.where(mask[None, None], scores, -1e9)
        p = _softmax(scores, axis=-1)
        o = torch.einsum("bhqk,bhkd->bhqd", p, v)
        return (lambda x, *d: x.permute(*d))(o, 0, 2, 1, 3).reshape(B, S, D) @ wo

    def _B_ref(x, w_gate, w_up, w_down):
        g = torch.einsum("bsd,df->bsf", x, w_gate)
        u = torch.einsum("bsd,df->bsf", x, w_up)
        h = _sigmoid(g) * u
        return torch.einsum("bsf,fd->bsd", h, w_down)

    x = A_x
    g = _sigmoid((x * gate_w).sum(-1, keepdims=True))
    a = _A_ref(x, A_wqkv, A_wo)
    b = _B_ref(x, B_w_gate, B_w_up, B_w_down)
    return g * a + (1 - g) * b
```

```asm
; @launch grid=(256,1,1) block=(256,1,1) lds=163840
.amdgcn_target "amdgcn-amd-amdhsa--gfx950"
.text
.globl gated_mix__sliding_block__glu_gated_glu__prompt_kernel
.p2align 8
.type gated_mix__sliding_block__glu_gated_glu__prompt_kernel,@function
gated_mix__sliding_block__glu_gated_glu__prompt_kernel:
    s_cmp_ge_u32 s2, 256
    s_cbranch_scc1 L_end
    s_load_dwordx16 s[48:63], s[0:1], 0
    s_load_dwordx4 s[64:67], s[0:1], 64
    s_load_dwordx2 s[68:69], s[0:1], 80
    v_lshrrev_b32 v1, 6, v0
    v_and_b32 v0, 63, v0
    v_readfirstlane_b32 s70, v1
    s_lshr_b32 s76, s2, 3
    s_lshl_b32 s94, s76, 2
    s_add_u32 s94, s94, s70
    s_getpc_b64 s[4:5]
L_pc:
    s_lshl_b32 s77, s94, 8
    v_lshl_add_u32 v1, v0, 7, s77
    s_cmp_lt_u32 s77, L_hot_end - L_pc - 256
    s_cbranch_scc0 L_nopf
    s_mov_b64 exec, 3
    global_load_dword v4, v1, s[4:5]
    s_mov_b64 exec, -1
L_nopf:
    s_and_b32 s77, s2, 1
    s_lshl_b32 s71, s77, 3
    s_and_b32 s77, s76, 7
    s_add_u32 s71, s71, s77
    s_bfe_u32 s72, s2, 0x20001
    s_lshl_b32 s72, s72, 2
    s_lshr_b32 s77, s76, 3
    s_add_u32 s72, s72, s77
    s_lshl_b32 s73, s72, 1
    s_add_u32 s73, s73, s71
    s_and_b32 s73, s73, 7
    s_lshl_b32 s84, s71, 2
    s_add_u32 s84, s84, s70
    v_lshrrev_b32 v1, 3, v0
    s_lshl_b32 s77, s84, 15
    v_lshl_add_u32 v1, v1, 10, s77
    v_and_b32 v2, 7, v0
    v_lshrrev_b32 v3, 4, v0
    v_xor_b32 v2, v2, v3
    v_lshl_add_u32 v6, v2, 4, v1
    v_xor_b32 v7, 64, v6
    v_add_u32 v7, 7168, v7
    v_add_u32 v8, 14336, v6
    v_add_u32 v9, 14336, v7
    v_lshrrev_b32 v10, 2, v0
    s_lshl_b32 s77, s70, 4
    v_add_u32 v10, s77, v10
    v_and_b32 v2, 3, v0
    v_lshlrev_b32 v2, 4, v2
    v_mul_u32_u24 v1, 3072, v10
    s_lshl_b32 s77, s72, 6
    v_add3_u32 v5, v1, v2, s77
    s_lshl_b32 s82, s70, 12
    s_mul_i32 s83, s70, 3072
    s_mov_b32 s10, 2097152
    s_mov_b32 s11, 0x20000
    s_mov_b32 s14, 1572864
    s_mov_b32 s15, 0x20000
    s_mov_b32 s34, 14680064
    s_mov_b32 s35, 0x20000
    s_mov_b32 s46, 1024
    s_mov_b32 s47, 0x20000
    v_lshlrev_b32 v11, 4, v0
    s_waitcnt lgkmcnt(0)
    s_mov_b64 s[8:9], s[48:49]
    s_mov_b64 s[12:13], s[50:51]
    s_add_u32 s79, s73, 0
    s_and_b32 s79, s79, 7
    s_lshl_b32 s80, s79, 7
    s_add_u32 m0, s82, 0
    s_mul_i32 s81, s79, 196608
    buffer_load_dwordx4 v6, s[8:11], s80 offen  lds
    buffer_load_dwordx4 v7, s[8:11], s80 offen offset:1024  lds
    buffer_load_dwordx4 v8, s[8:11], s80 offen offset:2048  lds
    buffer_load_dwordx4 v9, s[8:11], s80 offen offset:3072  lds
    s_add_u32 m0, s83, 16384
    s_nop 0
    buffer_load_dwordx4 v5, s[12:15], s81 offen offset:0  lds
    buffer_load_dwordx4 v5, s[12:15], s81 offen offset:1024  lds
    buffer_load_dwordx4 v5, s[12:15], s81 offen offset:2048  lds
    s_mov_b64 s[32:33], s[68:69]
    s_mov_b64 s[44:45], s[62:63]
    s_lshl_b32 s77, s70, 10
    s_add_u32 m0, s77, 114688
    s_cmp_lt_u32 s70, 2
    s_cselect_b32 s77, 0, 2147483648
    v_or_b32 v1, s77, v11
    s_cmp_eq_u32 s70, 3
    s_cselect_b32 s77, 116736, m0
    s_mov_b32 m0, s77
    s_nop 0
    buffer_load_dwordx4 v1, s[44:47], 0 offen lds
    v_mov_b32 v12, 0
    v_mov_b32 v13, 0
    v_mov_b32 v14, 0
    v_mov_b32 v15, 0
    s_or_b32 s77, s72, s70
    s_cmp_eq_u32 s77, 0
    s_cselect_b32 s78, 0, 2147483648
    s_lshl_b32 s77, s71, 12
    s_add_u32 s77, s77, 12582912
    s_or_b32 s77, s77, s78
    v_and_b32 v1, 31, v0
    v_lshl_add_u32 v1, v1, 7, s77
    v_mov_b32 v16, v1
    s_lshl_b32 s77, s71, 2
    s_or_b32 s77, s77, s78
    v_mov_b32 v17, s77
    s_sub_u32 s16, s56, 4096
    s_subb_u32 s17, s57, 0
    s_sub_u32 s20, s58, 4096
    s_subb_u32 s21, s59, 0
    s_mov_b64 s[24:25], s[60:61]
    s_mov_b64 s[28:29], s[52:53]
    s_mov_b64 s[36:37], s[64:65]
    s_mov_b64 s[40:41], s[66:67]
    s_mov_b32 s18, 1413120
    s_mov_b32 s19, 0x20000
    s_mov_b32 s22, 1413120
    s_mov_b32 s23, 0x20000
    s_mov_b32 s26, 1409024
    s_mov_b32 s27, 0x20000
    s_mov_b32 s30, 524288
    s_mov_b32 s31, 0x20000
    s_mov_b32 s38, 2097152
    s_mov_b32 s39, 0x20000
    s_mov_b32 s42, 256
    s_mov_b32 s43, 0x20000
    s_lshr_b32 s77, s72, 2
    s_mul_i32 s77, s77, 11
    s_and_b32 s78, s72, 3
    s_mul_i32 s79, s78, 3
    s_add_u32 s77, s77, s79
    s_cmp_eq_u32 s72, 15
    s_subb_u32 s85, s77, 0
    s_cmp_eq_u32 s78, 3
    s_cselect_b32 s79, 2147483648, 0
    s_cmp_eq_u32 s72, 14
    s_cselect_b32 s95, 2147483648, s79
    v_mul_u32_u24 v1, 2752, v10
    s_lshl_b32 s77, s85, 6
    s_add_u32 s77, s77, 4096
    v_add3_u32 v18, v1, v2, s77
    v_subrev_u32 v19, 960, v18
    v_subrev_u32 v20, 1920, v18
    v_or_b32 v20, s95, v20
    v_lshrrev_b32 v1, 5, v0
    v_lshlrev_b32 v1, 9, v1
    v_bfe_u32 v2, v0, 2, 2
    v_lshl_add_u32 v1, v2, 6, v1
    v_bfe_u32 v2, v0, 4, 1
    v_lshl_add_u32 v1, v2, 5, v1
    v_and_b32 v2, 1, v0
    v_lshl_add_u32 v1, v2, 4, v1
    v_bfe_u32 v2, v0, 1, 1
    v_lshl_add_u32 v22, v2, 3, v1
    v_add_u32 v23, 57344, v22
    v_add_u32 v24, 49152, v22
    v_and_b32 v1, 31, v0
    v_lshl_add_u32 v1, v1, 7, s82
    v_bfe_u32 v2, v0, 1, 3
    v_lshrrev_b32 v3, 5, v0
    v_xor_b32 v2, v2, v3
    v_lshl_add_u32 v248, v2, 4, v1
    v_xor_b32 v249, 32, v248
    v_xor_b32 v250, 64, v248
    v_xor_b32 v251, 96, v248
    v_add_u32 v252, 57344, v248
    v_add_u32 v253, 57344, v249
    v_add_u32 v254, 57344, v250
    v_add_u32 v255, 57344, v251
    s_lshl_b32 s77, s73, 7
    s_add_u32 s77, s77, 114688
    v_lshl_add_u32 v1, v3, 4, s77
    v_and_b32 v2, 27, v0
    v_cmp_eq_u32 vcc, 0, v2
    v_mov_b32 v10, 116736
    s_nop 0
    v_cndmask_b32 v10, v10, v1, vcc
    s_lshl_b32 s74, s71, 1
    s_lshr_b32 s77, s72, 3
    s_add_u32 s74, s74, s77
    s_and_b32 s75, s72, 7
    s_mov_b32 s86, 0xffff
    s_mov_b32 s87, 0xffff
    s_mov_b32 s88, 0xffff0000
    s_mov_b32 s89, 0xffff0000
    s_lshl_b32 s77, s71, 12
    s_add_u32 s77, s77, 12582912
    s_lshr_b32 s78, s72, 2
    s_lshl_b32 s78, s78, 7
    s_add_u32 s77, s77, s78
    s_lshr_b32 s79, s70, 1
    s_lshl_b32 s51, s79, 9
    s_add_u32 s51, s51, s77
    s_and_b32 s78, s72, 3
    s_lshl_b32 s78, s78, 2
    s_add_u32 s77, s77, s78
    s_add_u32 s48, s77, 2048
    s_sub_u32 s78, 2, s79
    s_lshl_b32 s79, s78, 12
    s_sub_u32 s77, s48, s79
    s_cmp_ge_u32 s71, s78
    s_cselect_b32 s49, s77, 2147483648
    s_cselect_b32 s50, 4, 0
    s_lshl_b32 s77, s72, 6
    s_add_u32 s77, s77, s84
    s_add_u32 s77, s77, s70
    s_sub_u32 s77, s77, 8
    s_lshl_b32 s77, s77, 12
    s_add_u32 s77, s77, 0
    s_cmp_eq_u32 s50, 0
    s_cselect_b32 s53, 2147483648, s77
    s_lshr_b32 s77, s74, 1
    s_lshl_b32 s77, s77, 12
    s_and_b32 s78, s74, 1
    s_lshl_b32 s78, s78, 9
    s_add_u32 s77, s77, s78
    s_add_u32 s52, s77, 12582912
    s_lshl_b32 s77, s84, 5
    s_lshl_b32 s78, s72, 1
    s_add_u32 s77, s77, s78
    s_lshl_b32 s77, s77, 10
    s_add_u32 s56, s77, 10485760
    s_mul_i32 s77, s74, 172
    s_mul_i32 s78, s70, 22
    s_add_u32 s77, s77, s78
    s_lshl_b32 s77, s77, 10
    s_add_u32 s57, s77, 4194304
    v_lshrrev_b32 v2, 3, v0
    s_lshl_b32 s78, s75, 7
    v_lshl_add_u32 v1, v2, 10, s78
    v_bfe_u32 v2, v0, 4, 1
    v_and_b32 v3, 7, v0
    v_lshl_add_u32 v1, v3, 4, v1
    v_lshlrev_b32 v3, 5, v2
    v_xor_b32 v26, v1, v3
    v_xor_b32 v27, 64, v26
    v_add_u32 v27, 7168, v27
    v_add_u32 v28, 14336, v26
    v_add_u32 v29, 14336, v27
    s_add_u32 s92, s82, 49152
    v_lshrrev_b32 v3, 4, v0
    v_lshl_add_u32 v30, v3, 10, s92
    v_bfe_u32 v1, v0, 2, 2
    v_lshl_add_u32 v30, v1, 7, v30
    v_and_b32 v1, 3, v0
    v_lshl_add_u32 v30, v1, 3, v30
    v_bfe_u32 v1, v0, 3, 2
    v_lshl_add_u32 v30, v1, 5, v30
    v_xor_b32 v31, 32, v30
    v_xor_b32 v32, 64, v30
    v_xor_b32 v33, 96, v30
    s_mul_i32 s6, s70, 360448
    s_lshl_b32 s7, s70, 17
    s_mul_i32 s77, s84, 86
    s_lshl_b32 s78, s85, 1
    s_add_u32 s77, s77, s78
    s_lshl_b32 s77, s77, 10
    s_add_u32 s77, s77, 4194304
    v_add_u32 v34, s77, v11
    v_add_u32 v35, 4096, v34
    v_or_b32 v35, s95, v35
    s_mov_b32 s90, 0xbfb8aa3b
    s_mov_b32 s91, 0xbfb8aa3b
    v_and_b32 v1, 7, v0
    v_lshlrev_b32 v1, 7, v1
    v_min_u32 v1, 700, v1
    v_bfe_u32 v2, v0, 3, 2
    s_lshl_b32 s77, s94, 2
    v_add_u32 v2, s77, v2
    v_mul_u32_u24 v2, 2752, v2
    s_lshr_b32 s77, s72, 2
    s_mul_i32 s77, s77, 704
    s_add_u32 s77, s77, 4096
    v_add3_u32 v36, v1, v2, s77
    s_lshr_b32 s78, s75, 2
    s_lshl_b32 s78, s78, 9
    v_lshrrev_b32 v2, 2, v0
    v_and_b32 v3, 3, v0
    v_lshlrev_b32 v3, 7, v3
    v_lshl_add_u32 v2, v2, 10, v3
    s_mul_i32 s77, s94, 11264
    s_add_u32 s77, s77, s78
    v_add_u32 v37, s77, v2
    s_lshl_b32 s77, s94, 12
    s_add_u32 s77, s77, s78
    v_add_u32 v38, s77, v2
    v_mov_b32 v1, 2147483648
    v_cmp_gt_u32 vcc, 32, v0
    s_nop 1
    v_cndmask_b32 v36, v1, v36, vcc
    v_cmp_gt_u32 vcc, 44, v0
    s_nop 1
    v_cndmask_b32 v37, v1, v37, vcc
    v_cmp_gt_u32 vcc, 16, v0
    s_nop 1
    v_cndmask_b32 v38, v1, v38, vcc
    s_lshr_b32 s77, s2, 3
    s_mul_i32 s78, s77, 64
    s_lshr_b32 s78, s78, 8
    s_mul_i32 s78, s78, 4
    s_sub_u32 s77, s77, s78
    s_add_u32 s59, s77, 2
    s_lshr_b32 s77, s2, 3
    s_mul_i32 s78, s77, 86
    s_lshr_b32 s78, s78, 8
    s_mul_i32 s78, s78, 3
    s_sub_u32 s77, s77, s78
    s_add_u32 s62, s77, 10
    v_and_b32 v1, 15, v0
    v_lshrrev_b32 v2, 4, v0
    v_lshlrev_b32 v1, 4, v1
    v_lshl_add_u32 v1, v2, 9, v1
    s_add_u32 s77, s70, 0
    s_bfe_u32 s78, s77, 0x10001
    s_mul_i32 s78, s78, 88064
    s_and_b32 s77, s77, 1
    s_lshl_b32 s77, s77, 8
    s_add_u32 s77, s77, s78
    s_add_u32 s77, s77, s57
    v_add_u32 v40, s77, v1
    s_add_u32 s77, s70, 1
    s_bfe_u32 s78, s77, 0x10001
    s_mul_i32 s78, s78, 88064
    s_and_b32 s77, s77, 1
    s_lshl_b32 s77, s77, 8
    s_add_u32 s77, s77, s78
    s_add_u32 s77, s77, s57
    v_add_u32 v41, s77, v1
    s_add_u32 s77, s70, 2
    s_bfe_u32 s78, s77, 0x10001
    s_mul_i32 s78, s78, 88064
    s_and_b32 s77, s77, 1
    s_lshl_b32 s77, s77, 8
    s_add_u32 s77, s77, s78
    s_add_u32 s77, s77, s57
    v_add_u32 v42, s77, v1
    s_add_u32 s77, s70, 3
    s_bfe_u32 s78, s77, 0x10001
    s_mul_i32 s78, s78, 88064
    s_and_b32 s77, s77, 1
    s_lshl_b32 s77, s77, 8
    s_add_u32 s77, s77, s78
    s_add_u32 s77, s77, s57
    v_add_u32 v43, s77, v1
    s_lshl_b32 s77, s74, 1
    s_lshr_b32 s78, s70, 1
    s_add_u32 s77, s77, s78
    s_lshl_b32 s77, s77, 15
    s_and_b32 s78, s70, 1
    s_lshl_b32 s78, s78, 8
    s_add_u32 s77, s77, s78
    s_add_u32 s77, s77, 10485760
    v_and_b32 v2, 15, v0
    v_lshrrev_b32 v3, 4, v0
    v_lshl_add_u32 v25, v2, 4, s77
    v_lshl_add_u32 v25, v3, 9, v25
    s_add_u32 s77, s70, 1
    s_and_b32 s77, s77, 3
    s_mul_i32 s77, s77, 12288
    s_add_u32 s77, s77, 65536
    v_add_u32 v44, s77, v11
    s_add_u32 s77, s70, 2
    s_and_b32 s77, s77, 3
    s_mul_i32 s77, s77, 12288
    s_add_u32 s77, s77, 69632
    v_add_u32 v45, s77, v11
    s_add_u32 s77, s70, 3
    s_and_b32 s77, s77, 3
    s_mul_i32 s77, s77, 12288
    s_add_u32 s77, s77, 73728
    v_add_u32 v46, s77, v11
    s_mul_i32 s77, s70, 12288
    s_add_u32 s77, s77, 65536
    v_add_u32 v39, s77, v11
    s_lshl_b32 s77, s70, 4
    v_add_u32 v2, s77, v2
    s_lshl_b32 s77, s74, 16
    s_lshl_b32 s78, s75, 7
    s_add_u32 s77, s77, s78
    v_lshl_add_u32 v47, v2, 10, s77
    v_lshrrev_b32 v1, 1, v3
    v_lshl_add_u32 v47, v1, 4, v47
    v_and_b32 v1, 1, v3
    v_lshl_add_u32 v47, v1, 5, v47
    v_and_b32 v1, 3, v0
    v_bfe_u32 v2, v0, 3, 1
    v_mul_u32_u24 v2, 8128, v2
    v_sub_u32 v47, v47, v2
    s_add_u32 s77, s52, 1024
    v_lshl_add_u32 v48, v1, 7, s77
    s_add_u32 s79, s73, 1
    s_and_b32 s79, s79, 7
    s_lshl_b32 s80, s79, 7
    s_add_u32 m0, s82, 28672
    s_mul_i32 s81, s79, 196608
    buffer_load_dwordx4 v6, s[8:11], s80 offen  lds
    buffer_load_dwordx4 v7, s[8:11], s80 offen offset:1024  lds
    buffer_load_dwordx4 v8, s[8:11], s80 offen offset:2048  lds
    buffer_load_dwordx4 v9, s[8:11], s80 offen offset:3072  lds
    s_add_u32 m0, s83, 45056
    s_nop 0
    buffer_load_dwordx4 v5, s[12:15], s81 offen offset:0  lds
    buffer_load_dwordx4 v5, s[12:15], s81 offen offset:1024  lds
    buffer_load_dwordx4 v5, s[12:15], s81 offen offset:2048  lds
    s_mov_b64 exec, 0
    s_cmp_eq_u32 s70, 0
    s_cbranch_scc1 L_pad_0
    s_cmp_eq_u32 s70, 1
    s_cbranch_scc1 L_pad_1
    s_cmp_eq_u32 s70, 2
    s_cbranch_scc1 L_pad_2
    s_branch L_pad_3
L_warm_back:
    s_mov_b64 exec, -1
    buffer_store_dwordx4 v[12:15], v16, s[32:35], 0 offen sc1
    s_branch L_main
.p2align 12
L_main:
    s_waitcnt vmcnt(8)
    s_barrier
    ds_read_b128 a[0:3], v248 offset:0
    ds_read_b64_tr_b16 a[200:201], v22 offset:16384
    ds_read_b64_tr_b16 a[202:203], v22 offset:16640
    ds_read_b64_tr_b16 a[204:205], v22 offset:17408
    ds_read_b64_tr_b16 a[206:207], v22 offset:17664
    ds_read_b64_tr_b16 a[208:209], v22 offset:18432
    ds_read_b64_tr_b16 a[210:211], v22 offset:18688
    ds_read_b128 a[212:215], v10 offset:0
    s_waitcnt lgkmcnt(3)
    v_mfma_f32_32x32x16_bf16 v[224:239], a[200:203], a[0:3], 0
    ds_read_b128 a[4:7], v249 offset:0
    ds_read_b64_tr_b16 a[216:217], v22 offset:19456
    ds_read_b64_tr_b16 a[218:219], v22 offset:19712
    s_add_u32 s79, s73, 2
    s_and_b32 s79, s79, 7
    s_lshl_b32 s80, s79, 7
    s_add_u32 m0, s82, 57344
    s_mul_i32 s81, s79, 196608
    buffer_load_dwordx4 v6, s[8:11], s80 offen  lds
    v_mfma_f32_32x32x16_bf16 v[208:223], a[204:207], a[0:3], 0
    ds_read_b64_tr_b16 a[220:221], v22 offset:20480
    ds_read_b64_tr_b16 a[222:223], v22 offset:20736
    s_waitcnt lgkmcnt(5)
    v_mfma_f32_32x32x16_bf16 v[192:207], a[0:3], a[208:211], 0
    ds_read_b64_tr_b16 a[200:201], v22 offset:21504
    ds_read_b64_tr_b16 a[202:203], v22 offset:21760
    buffer_load_dwordx4 v7, s[8:11], s80 offen offset:1024  lds
    v_mfma_f32_32x32x16_bf16 v[176:191], a[212:215], a[0:3], 0
    ds_read_b128 a[204:207], v10 offset:32
    s_waitcnt lgkmcnt(3)
    v_mfma_f32_32x32x16_bf16 v[224:239], a[216:219], a[4:7], v[224:239]
    ds_read_b128 a[8:11], v250 offset:0
    ds_read_b64_tr_b16 a[208:209], v22 offset:22528
    ds_read_b64_tr_b16 a[210:211], v22 offset:22784
    buffer_load_dwordx4 v8, s[8:11], s80 offen offset:2048  lds
    v_mfma_f32_32x32x16_bf16 v[208:223], a[220:223], a[4:7], v[208:223]
    ds_read_b64_tr_b16 a[212:213], v22 offset:23552
    ds_read_b64_tr_b16 a[214:215], v22 offset:23808
    s_waitcnt lgkmcnt(5)
    v_mfma_f32_32x32x16_bf16 v[192:207], a[4:7], a[200:203], v[192:207]
    ds_read_b64_tr_b16 a[216:217], v22 offset:24576
    ds_read_b64_tr_b16 a[218:219], v22 offset:24832
    buffer_load_dwordx4 v9, s[8:11], s80 offen offset:3072  lds
    v_mfma_f32_32x32x16_bf16 v[176:191], a[204:207], a[4:7], v[176:191]
    ds_read_b128 a[220:223], v10 offset:64
    s_waitcnt lgkmcnt(3)
    v_mfma_f32_32x32x16_bf16 v[224:239], a[208:211], a[8:11], v[224:239]
    ds_read_b128 a[12:15], v251 offset:0
    ds_read_b64_tr_b16 a[200:201], v22 offset:25600
    ds_read_b64_tr_b16 a[202:203], v22 offset:25856
    s_add_u32 m0, s83, 73728
    s_nop 0
    buffer_load_dwordx4 v5, s[12:15], s81 offen offset:0  lds
    v_mfma_f32_32x32x16_bf16 v[208:223], a[212:215], a[8:11], v[208:223]
    ds_read_b64_tr_b16 a[204:205], v22 offset:26624
    ds_read_b64_tr_b16 a[206:207], v22 offset:26880
    s_waitcnt lgkmcnt(5)
    v_mfma_f32_32x32x16_bf16 v[192:207], a[8:11], a[216:219], v[192:207]
    ds_read_b64_tr_b16 a[208:209], v22 offset:27648
    ds_read_b64_tr_b16 a[210:211], v22 offset:27904
    buffer_load_dwordx4 v5, s[12:15], s81 offen offset:1024  lds
    v_mfma_f32_32x32x16_bf16 v[176:191], a[220:223], a[8:11], v[176:191]
    ds_read_b128 a[212:215], v10 offset:96
    s_waitcnt lgkmcnt(3)
    v_mfma_f32_32x32x16_bf16 v[224:239], a[200:203], a[12:15], v[224:239]
    buffer_load_dwordx4 v5, s[12:15], s81 offen offset:2048  lds
    s_waitcnt vmcnt(8)
    s_barrier
    ds_read_b128 a[16:19], v248 offset:28672
    ds_read_b64_tr_b16 a[216:217], v22 offset:45056
    ds_read_b64_tr_b16 a[218:219], v22 offset:45312
    s_add_u32 s79, s73, 3
    s_and_b32 s79, s79, 7
    s_lshl_b32 s80, s79, 7
    s_add_u32 m0, s82, 86016
    s_mul_i32 s81, s79, 196608
    buffer_load_dwordx4 v6, s[8:11], s80 offen  lds
    v_mfma_f32_32x32x16_bf16 v[208:223], a[204:207], a[12:15], v[208:223]
    ds_read_b64_tr_b16 a[220:221], v22 offset:46080
    ds_read_b64_tr_b16 a[222:223], v22 offset:46336
    s_waitcnt lgkmcnt(5)
    v_mfma_f32_32x32x16_bf16 v[192:207], a[12:15], a[208:211], v[192:207]
    ds_read_b64_tr_b16 a[200:201], v22 offset:47104
    ds_read_b64_tr_b16 a[202:203], v22 offset:47360
    buffer_load_dwordx4 v7, s[8:11], s80 offen offset:1024  lds
    v_mfma_f32_32x32x16_bf16 v[176:191], a[212:215], a[12:15], v[176:191]
    ds_read_b128 a[204:207], v10 offset:128
    s_waitcnt lgkmcnt(3)
    v_mfma_f32_32x32x16_bf16 v[224:239], a[216:219], a[16:19], v[224:239]
    ds_read_b128 a[20:23], v249 offset:28672
    ds_read_b64_tr_b16 a[208:209], v22 offset:48128
    ds_read_b64_tr_b16 a[210:211], v22 offset:48384
    buffer_load_dwordx4 v8, s[8:11], s80 offen offset:2048  lds
    v_mfma_f32_32x32x16_bf16 v[208:223], a[220:223], a[16:19], v[208:223]
    ds_read_b64_tr_b16 a[212:213], v22 offset:49152
    ds_read_b64_tr_b16 a[214:215], v22 offset:49408
    s_waitcnt lgkmcnt(5)
    v_mfma_f32_32x32x16_bf16 v[192:207], a[16:19], a[200:203], v[192:207]
    ds_read_b64_tr_b16 a[216:217], v22 offset:50176
    ds_read_b64_tr_b16 a[218:219], v22 offset:50432
    buffer_load_dwordx4 v9, s[8:11], s80 offen offset:3072  lds
    v_mfma_f32_32x32x16_bf16 v[176:191], a[204:207], a[16:19], v[176:191]
    ds_read_b128 a[220:223], v10 offset:160
    s_waitcnt lgkmcnt(3)
    v_mfma_f32_32x32x16_bf16 v[224:239], a[208:211], a[20:23], v[224:239]
    ds_read_b128 a[24:27], v250 offset:28672
    ds_read_b64_tr_b16 a[200:201], v22 offset:51200
    ds_read_b64_tr_b16 a[202:203], v22 offset:51456
    s_add_u32 m0, s83, 102400
    s_nop 0
    buffer_load_dwordx4 v5, s[12:15], s81 offen offset:0  lds
    v_mfma_f32_32x32x16_bf16 v[208:223], a[212:215], a[20:23], v[208:223]
    ds_read_b64_tr_b16 a[204:205], v22 offset:52224
    ds_read_b64_tr_b16 a[206:207], v22 offset:52480
    s_waitcnt lgkmcnt(5)
    v_mfma_f32_32x32x16_bf16 v[192:207], a[20:23], a[216:219], v[192:207]
    ds_read_b64_tr_b16 a[208:209], v22 offset:53248
    ds_read_b64_tr_b16 a[210:211], v22 offset:53504
    buffer_load_dwordx4 v5, s[12:15], s81 offen offset:1024  lds
    v_mfma_f32_32x32x16_bf16 v[176:191], a[220:223], a[20:23], v[176:191]
    ds_read_b128 a[212:215], v10 offset:192
    s_waitcnt lgkmcnt(3)
    v_mfma_f32_32x32x16_bf16 v[224:239], a[200:203], a[24:27], v[224:239]
    ds_read_b128 a[28:31], v251 offset:28672
    ds_read_b64_tr_b16 a[216:217], v22 offset:54272
    ds_read_b64_tr_b16 a[218:219], v22 offset:54528
    buffer_load_dwordx4 v5, s[12:15], s81 offen offset:2048  lds
    v_mfma_f32_32x32x16_bf16 v[208:223], a[204:207], a[24:27], v[208:223]
    ds_read_b64_tr_b16 a[220:221], v22 offset:55296
    ds_read_b64_tr_b16 a[222:223], v22 offset:55552
    s_waitcnt lgkmcnt(5)
    v_mfma_f32_32x32x16_bf16 v[192:207], a[24:27], a[208:211], v[192:207]
    ds_read_b64_tr_b16 a[200:201], v22 offset:56320
    ds_read_b64_tr_b16 a[202:203], v22 offset:56576
    v_mfma_f32_32x32x16_bf16 v[176:191], a[212:215], a[24:27], v[176:191]
    ds_read_b128 a[204:207], v10 offset:224
    s_waitcnt lgkmcnt(3)
    v_mfma_f32_32x32x16_bf16 v[224:239], a[216:219], a[28:31], v[224:239]
    s_waitcnt vmcnt(7)
    s_barrier
    v_mov_b32 v16, 1
    buffer_store_dword v16, v17, s[40:43], 0 offen sc1
    ds_read_b128 a[32:35], v252 offset:0
    ds_read_b64_tr_b16 a[208:209], v23 offset:16384
    ds_read_b64_tr_b16 a[210:211], v23 offset:16640
    s_add_u32 s79, s73, 4
    s_and_b32 s79, s79, 7
    s_lshl_b32 s80, s79, 7
    s_add_u32 m0, s82, 0
    s_mul_i32 s81, s79, 196608
    buffer_load_dwordx4 v6, s[8:11], s80 offen  lds
    v_mfma_f32_32x32x16_bf16 v[208:223], a[220:223], a[28:31], v[208:223]
    ds_read_b64_tr_b16 a[212:213], v23 offset:17408
    ds_read_b64_tr_b16 a[214:215], v23 offset:17664
    s_waitcnt lgkmcnt(5)
    v_mfma_f32_32x32x16_bf16 v[192:207], a[28:31], a[200:203], v[192:207]
    ds_read_b64_tr_b16 a[216:217], v23 offset:18432
    ds_read_b64_tr_b16 a[218:219], v23 offset:18688
    buffer_load_dwordx4 v7, s[8:11], s80 offen offset:1024  lds
    v_mfma_f32_32x32x16_bf16 v[176:191], a[204:207], a[28:31], v[176:191]
    ds_read_b128 a[220:223], v10 offset:256
    s_waitcnt lgkmcnt(3)
    v_mfma_f32_32x32x16_bf16 v[224:239], a[208:211], a[32:35], v[224:239]
    ds_read_b128 a[36:39], v253 offset:0
    ds_read_b64_tr_b16 a[200:201], v23 offset:19456
    ds_read_b64_tr_b16 a[202:203], v23 offset:19712
    buffer_load_dwordx4 v8, s[8:11], s80 offen offset:2048  lds
    v_mfma_f32_32x32x16_bf16 v[208:223], a[212:215], a[32:35], v[208:223]
    ds_read_b64_tr_b16 a[204:205], v23 offset:20480
    ds_read_b64_tr_b16 a[206:207], v23 offset:20736
    s_waitcnt lgkmcnt(5)
    v_mfma_f32_32x32x16_bf16 v[192:207], a[32:35], a[216:219], v[192:207]
    ds_read_b64_tr_b16 a[208:209], v23 offset:21504
    ds_read_b64_tr_b16 a[210:211], v23 offset:21760
    buffer_load_dwordx4 v9, s[8:11], s80 offen offset:3072  lds
    v_mfma_f32_32x32x16_bf16 v[176:191], a[220:223], a[32:35], v[176:191]
    ds_read_b128 a[212:215], v10 offset:288
    s_waitcnt lgkmcnt(3)
    v_mfma_f32_32x32x16_bf16 v[224:239], a[200:203], a[36:39], v[224:239]
    ds_read_b128 a[40:43], v254 offset:0
    ds_read_b64_tr_b16 a[216:217], v23 offset:22528
    ds_read_b64_tr_b16 a[218:219], v23 offset:22784
    s_add_u32 m0, s83, 16384
    s_nop 0
    buffer_load_dwordx4 v5, s[12:15], s81 offen offset:0  lds
    v_mfma_f32_32x32x16_bf16 v[208:223], a[204:207], a[36:39], v[208:223]
    ds_read_b64_tr_b16 a[220:221], v23 offset:23552
    ds_read_b64_tr_b16 a[222:223], v23 offset:23808
    s_waitcnt lgkmcnt(5)
    v_mfma_f32_32x32x16_bf16 v[192:207], a[36:39], a[208:211], v[192:207]
    ds_read_b64_tr_b16 a[200:201], v23 offset:24576
    ds_read_b64_tr_b16 a[202:203], v23 offset:24832
    buffer_load_dwordx4 v5, s[12:15], s81 offen offset:1024  lds
    v_mfma_f32_32x32x16_bf16 v[176:191], a[212:215], a[36:39], v[176:191]
    ds_read_b128 a[204:207], v10 offset:320
    s_waitcnt lgkmcnt(3)
    v_mfma_f32_32x32x16_bf16 v[224:239], a[216:219], a[40:43], v[224:239]
    ds_read_b128 a[44:47], v255 offset:0
    ds_read_b64_tr_b16 a[208:209], v23 offset:25600
    ds_read_b64_tr_b16 a[210:211], v23 offset:25856
    buffer_load_dwordx4 v5, s[12:15], s81 offen offset:2048  lds
    v_mfma_f32_32x32x16_bf16 v[208:223], a[220:223], a[40:43], v[208:223]
    ds_read_b64_tr_b16 a[212:213], v23 offset:26624
    ds_read_b64_tr_b16 a[214:215], v23 offset:26880
    s_waitcnt lgkmcnt(5)
    v_mfma_f32_32x32x16_bf16 v[192:207], a[40:43], a[200:203], v[192:207]
    ds_read_b64_tr_b16 a[216:217], v23 offset:27648
    ds_read_b64_tr_b16 a[218:219], v23 offset:27904
    s_cmp_eq_u32 s59, 2
    s_cselect_b32 s58, 0, 2147483648
    v_or_b32 v2, s58, v36
    buffer_load_dword v21, v2, s[16:19], 0 offen
    buffer_load_dword v21, v2, s[20:23], 0 offen
    v_mfma_f32_32x32x16_bf16 v[176:191], a[204:207], a[40:43], v[176:191]
    ds_read_b128 a[220:223], v10 offset:352
    s_waitcnt lgkmcnt(3)
    v_mfma_f32_32x32x16_bf16 v[224:239], a[208:211], a[44:47], v[224:239]
    s_waitcnt vmcnt(10)
    s_barrier
    ds_read_b128 a[48:51], v252 offset:28672
    ds_read_b64_tr_b16 a[200:201], v23 offset:45056
    ds_read_b64_tr_b16 a[202:203], v23 offset:45312
    s_add_u32 s79, s73, 5
    s_and_b32 s79, s79, 7
    s_lshl_b32 s80, s79, 7
    s_add_u32 m0, s82, 28672
    s_mul_i32 s81, s79, 196608
    buffer_load_dwordx4 v6, s[8:11], s80 offen  lds
    v_mfma_f32_32x32x16_bf16 v[208:223], a[212:215], a[44:47], v[208:223]
    ds_read_b64_tr_b16 a[204:205], v23 offset:46080
    ds_read_b64_tr_b16 a[206:207], v23 offset:46336
    s_waitcnt lgkmcnt(5)
    v_mfma_f32_32x32x16_bf16 v[192:207], a[44:47], a[216:219], v[192:207]
    ds_read_b64_tr_b16 a[208:209], v23 offset:47104
    ds_read_b64_tr_b16 a[210:211], v23 offset:47360
    buffer_load_dwordx4 v7, s[8:11], s80 offen offset:1024  lds
    v_mfma_f32_32x32x16_bf16 v[176:191], a[220:223], a[44:47], v[176:191]
    ds_read_b128 a[212:215], v10 offset:384
    s_waitcnt lgkmcnt(3)
    v_mfma_f32_32x32x16_bf16 v[224:239], a[200:203], a[48:51], v[224:239]
    ds_read_b128 a[52:55], v253 offset:28672
    ds_read_b64_tr_b16 a[216:217], v23 offset:48128
    ds_read_b64_tr_b16 a[218:219], v23 offset:48384
    buffer_load_dwordx4 v8, s[8:11], s80 offen offset:2048  lds
    v_mfma_f32_32x32x16_bf16 v[208:223], a[204:207], a[48:51], v[208:223]
    ds_read_b64_tr_b16 a[220:221], v23 offset:49152
    ds_read_b64_tr_b16 a[222:223], v23 offset:49408
    s_waitcnt lgkmcnt(5)
    v_mfma_f32_32x32x16_bf16 v[192:207], a[48:51], a[208:211], v[192:207]
    ds_read_b64_tr_b16 a[200:201], v23 offset:50176
    ds_read_b64_tr_b16 a[202:203], v23 offset:50432
    buffer_load_dwordx4 v9, s[8:11], s80 offen offset:3072  lds
    v_mfma_f32_32x32x16_bf16 v[176:191], a[212:215], a[48:51], v[176:191]
    ds_read_b128 a[204:207], v10 offset:416
    s_waitcnt lgkmcnt(3)
    v_mfma_f32_32x32x16_bf16 v[224:239], a[216:219], a[52:55], v[224:239]
    ds_read_b128 a[56:59], v254 offset:28672
    ds_read_b64_tr_b16 a[208:209], v23 offset:51200
    ds_read_b64_tr_b16 a[210:211], v23 offset:51456
    s_add_u32 m0, s83, 45056
    s_nop 0
    buffer_load_dwordx4 v5, s[12:15], s81 offen offset:0  lds
    v_mfma_f32_32x32x16_bf16 v[208:223], a[220:223], a[52:55], v[208:223]
    ds_read_b64_tr_b16 a[212:213], v23 offset:52224
    ds_read_b64_tr_b16 a[214:215], v23 offset:52480
    s_waitcnt lgkmcnt(5)
    v_mfma_f32_32x32x16_bf16 v[192:207], a[52:55], a[200:203], v[192:207]
    ds_read_b64_tr_b16 a[216:217], v23 offset:53248
    ds_read_b64_tr_b16 a[218:219], v23 offset:53504
    buffer_load_dwordx4 v5, s[12:15], s81 offen offset:1024  lds
    v_mfma_f32_32x32x16_bf16 v[176:191], a[204:207], a[52:55], v[176:191]
    ds_read_b128 a[220:223], v10 offset:448
    s_waitcnt lgkmcnt(3)
    v_mfma_f32_32x32x16_bf16 v[224:239], a[208:211], a[56:59], v[224:239]
    ds_read_b128 a[60:63], v255 offset:28672
    ds_read_b64_tr_b16 a[200:201], v23 offset:54272
    ds_read_b64_tr_b16 a[202:203], v23 offset:54528
    buffer_load_dwordx4 v5, s[12:15], s81 offen offset:2048  lds
    v_mfma_f32_32x32x16_bf16 v[208:223], a[212:215], a[56:59], v[208:223]
    ds_read_b64_tr_b16 a[204:205], v23 offset:55296
    ds_read_b64_tr_b16 a[206:207], v23 offset:55552
    s_waitcnt lgkmcnt(5)
    v_mfma_f32_32x32x16_bf16 v[192:207], a[56:59], a[216:219], v[192:207]
    ds_read_b64_tr_b16 a[208:209], v23 offset:56320
    ds_read_b64_tr_b16 a[210:211], v23 offset:56576
    s_cmp_eq_u32 s59, 3
    s_cselect_b32 s58, 0, 2147483648
    v_or_b32 v2, s58, v36
    buffer_load_dword v21, v2, s[16:19], 0 offen
    buffer_load_dword v21, v2, s[20:23], 0 offen
    v_mfma_f32_32x32x16_bf16 v[176:191], a[220:223], a[56:59], v[176:191]
    ds_read_b128 a[212:215], v10 offset:480
    s_waitcnt lgkmcnt(3)
    v_mfma_f32_32x32x16_bf16 v[224:239], a[200:203], a[60:63], v[224:239]
    s_waitcnt vmcnt(11)
    s_barrier
    ds_read_b128 a[64:67], v248 offset:0
    ds_read_b64_tr_b16 a[216:217], v22 offset:16384
    ds_read_b64_tr_b16 a[218:219], v22 offset:16640
    s_add_u32 s79, s73, 6
    s_and_b32 s79, s79, 7
    s_lshl_b32 s80, s79, 7
    s_add_u32 m0, s82, 57344
    s_mul_i32 s81, s79, 196608
    buffer_load_dwordx4 v6, s[8:11], s80 offen  lds
    v_mfma_f32_32x32x16_bf16 v[208:223], a[204:207], a[60:63], v[208:223]
    ds_read_b64_tr_b16 a[220:221], v22 offset:17408
    ds_read_b64_tr_b16 a[222:223], v22 offset:17664
    s_waitcnt lgkmcnt(5)
    v_mfma_f32_32x32x16_bf16 v[192:207], a[60:63], a[208:211], v[192:207]
    ds_read_b64_tr_b16 a[200:201], v22 offset:18432
    ds_read_b64_tr_b16 a[202:203], v22 offset:18688
    buffer_load_dwordx4 v7, s[8:11], s80 offen offset:1024  lds
    v_mfma_f32_32x32x16_bf16 v[176:191], a[212:215], a[60:63], v[176:191]
    ds_read_b128 a[204:207], v10 offset:512
    s_waitcnt lgkmcnt(3)
    v_mfma_f32_32x32x16_bf16 v[224:239], a[216:219], a[64:67], v[224:239]
    ds_read_b128 a[68:71], v249 offset:0
    ds_read_b64_tr_b16 a[208:209], v22 offset:19456
    ds_read_b64_tr_b16 a[210:211], v22 offset:19712
    buffer_load_dwordx4 v8, s[8:11], s80 offen offset:2048  lds
    v_mfma_f32_32x32x16_bf16 v[208:223], a[220:223], a[64:67], v[208:223]
    ds_read_b64_tr_b16 a[212:213], v22 offset:20480
    ds_read_b64_tr_b16 a[214:215], v22 offset:20736
    s_waitcnt lgkmcnt(5)
    v_mfma_f32_32x32x16_bf16 v[192:207], a[64:67], a[200:203], v[192:207]
    ds_read_b64_tr_b16 a[216:217], v22 offset:21504
    ds_read_b64_tr_b16 a[218:219], v22 offset:21760
    buffer_load_dwordx4 v9, s[8:11], s80 offen offset:3072  lds
    v_mfma_f32_32x32x16_bf16 v[176:191], a[204:207], a[64:67], v[176:191]
    ds_read_b128 a[220:223], v10 offset:544
    s_waitcnt lgkmcnt(3)
    v_mfma_f32_32x32x16_bf16 v[224:239], a[208:211], a[68:71], v[224:239]
    ds_read_b128 a[72:75], v250 offset:0
    ds_read_b64_tr_b16 a[200:201], v22 offset:22528
    ds_read_b64_tr_b16 a[202:203], v22 offset:22784
    s_add_u32 m0, s83, 73728
    s_nop 0
    buffer_load_dwordx4 v5, s[12:15], s81 offen offset:0  lds
    v_mfma_f32_32x32x16_bf16 v[208:223], a[212:215], a[68:71], v[208:223]
    ds_read_b64_tr_b16 a[204:205], v22 offset:23552
    ds_read_b64_tr_b16 a[206:207], v22 offset:23808
    s_waitcnt lgkmcnt(5)
    v_mfma_f32_32x32x16_bf16 v[192:207], a[68:71], a[216:219], v[192:207]
    ds_read_b64_tr_b16 a[208:209], v22 offset:24576
    ds_read_b64_tr_b16 a[210:211], v22 offset:24832
    buffer_load_dwordx4 v5, s[12:15], s81 offen offset:1024  lds
    v_mfma_f32_32x32x16_bf16 v[176:191], a[220:223], a[68:71], v[176:191]
    ds_read_b128 a[212:215], v10 offset:576
    s_waitcnt lgkmcnt(3)
    v_mfma_f32_32x32x16_bf16 v[224:239], a[200:203], a[72:75], v[224:239]
    ds_read_b128 a[76:79], v251 offset:0
    ds_read_b64_tr_b16 a[216:217], v22 offset:25600
    ds_read_b64_tr_b16 a[218:219], v22 offset:25856
    buffer_load_dwordx4 v5, s[12:15], s81 offen offset:2048  lds
    v_mfma_f32_32x32x16_bf16 v[208:223], a[204:207], a[72:75], v[208:223]
    ds_read_b64_tr_b16 a[220:221], v22 offset:26624
    ds_read_b64_tr_b16 a[222:223], v22 offset:26880
    s_waitcnt lgkmcnt(5)
    v_mfma_f32_32x32x16_bf16 v[192:207], a[72:75], a[208:211], v[192:207]
    ds_read_b64_tr_b16 a[200:201], v22 offset:27648
    ds_read_b64_tr_b16 a[202:203], v22 offset:27904
    s_cmp_eq_u32 s59, 4
    s_cselect_b32 s58, 0, 2147483648
    v_or_b32 v2, s58, v36
    buffer_load_dword v21, v2, s[16:19], 0 offen
    buffer_load_dword v21, v2, s[20:23], 0 offen
    v_mfma_f32_32x32x16_bf16 v[176:191], a[212:215], a[72:75], v[176:191]
    ds_read_b128 a[204:207], v10 offset:608
    s_waitcnt lgkmcnt(3)
    v_mfma_f32_32x32x16_bf16 v[224:239], a[216:219], a[76:79], v[224:239]
    s_waitcnt vmcnt(11)
    s_barrier
    ds_read_b128 a[80:83], v248 offset:28672
    ds_read_b64_tr_b16 a[208:209], v22 offset:45056
    ds_read_b64_tr_b16 a[210:211], v22 offset:45312
    s_add_u32 s79, s73, 7
    s_and_b32 s79, s79, 7
    s_lshl_b32 s80, s79, 7
    s_add_u32 m0, s82, 86016
    s_mul_i32 s81, s79, 196608
    buffer_load_dwordx4 v6, s[8:11], s80 offen  lds
    v_mfma_f32_32x32x16_bf16 v[208:223], a[220:223], a[76:79], v[208:223]
    ds_read_b64_tr_b16 a[212:213], v22 offset:46080
    ds_read_b64_tr_b16 a[214:215], v22 offset:46336
    s_waitcnt lgkmcnt(5)
    v_mfma_f32_32x32x16_bf16 v[192:207], a[76:79], a[200:203], v[192:207]
    ds_read_b64_tr_b16 a[216:217], v22 offset:47104
    ds_read_b64_tr_b16 a[218:219], v22 offset:47360
    buffer_load_dwordx4 v7, s[8:11], s80 offen offset:1024  lds
    v_mfma_f32_32x32x16_bf16 v[176:191], a[204:207], a[76:79], v[176:191]
    ds_read_b128 a[220:223], v10 offset:640
    s_waitcnt lgkmcnt(3)
    v_mfma_f32_32x32x16_bf16 v[224:239], a[208:211], a[80:83], v[224:239]
    ds_read_b128 a[84:87], v249 offset:28672
    ds_read_b64_tr_b16 a[200:201], v22 offset:48128
    ds_read_b64_tr_b16 a[202:203], v22 offset:48384
    buffer_load_dwordx4 v8, s[8:11], s80 offen offset:2048  lds
    v_mfma_f32_32x32x16_bf16 v[208:223], a[212:215], a[80:83], v[208:223]
    ds_read_b64_tr_b16 a[204:205], v22 offset:49152
    ds_read_b64_tr_b16 a[206:207], v22 offset:49408
    s_waitcnt lgkmcnt(5)
    v_mfma_f32_32x32x16_bf16 v[192:207], a[80:83], a[216:219], v[192:207]
    ds_read_b64_tr_b16 a[208:209], v22 offset:50176
    ds_read_b64_tr_b16 a[210:211], v22 offset:50432
    buffer_load_dwordx4 v9, s[8:11], s80 offen offset:3072  lds
    v_mfma_f32_32x32x16_bf16 v[176:191], a[220:223], a[80:83], v[176:191]
    ds_read_b128 a[212:215], v10 offset:672
    s_waitcnt lgkmcnt(3)
    v_mfma_f32_32x32x16_bf16 v[224:239], a[200:203], a[84:87], v[224:239]
    ds_read_b128 a[88:91], v250 offset:28672
    ds_read_b64_tr_b16 a[216:217], v22 offset:51200
    ds_read_b64_tr_b16 a[218:219], v22 offset:51456
    s_add_u32 m0, s83, 102400
    s_nop 0
    buffer_load_dwordx4 v5, s[12:15], s81 offen offset:0  lds
    v_mfma_f32_32x32x16_bf16 v[208:223], a[204:207], a[84:87], v[208:223]
    ds_read_b64_tr_b16 a[220:221], v22 offset:52224
    ds_read_b64_tr_b16 a[222:223], v22 offset:52480
    s_waitcnt lgkmcnt(5)
    v_mfma_f32_32x32x16_bf16 v[192:207], a[84:87], a[208:211], v[192:207]
    ds_read_b64_tr_b16 a[200:201], v22 offset:53248
    ds_read_b64_tr_b16 a[202:203], v22 offset:53504
    buffer_load_dwordx4 v5, s[12:15], s81 offen offset:1024  lds
    v_mfma_f32_32x32x16_bf16 v[176:191], a[212:215], a[84:87], v[176:191]
    ds_read_b128 a[204:207], v10 offset:704
    s_waitcnt lgkmcnt(3)
    v_mfma_f32_32x32x16_bf16 v[224:239], a[216:219], a[88:91], v[224:239]
    ds_read_b128 a[92:95], v251 offset:28672
    ds_read_b64_tr_b16 a[208:209], v22 offset:54272
    ds_read_b64_tr_b16 a[210:211], v22 offset:54528
    buffer_load_dwordx4 v5, s[12:15], s81 offen offset:2048  lds
    v_mfma_f32_32x32x16_bf16 v[208:223], a[220:223], a[88:91], v[208:223]
    ds_read_b64_tr_b16 a[212:213], v22 offset:55296
    ds_read_b64_tr_b16 a[214:215], v22 offset:55552
    s_waitcnt lgkmcnt(5)
    v_mfma_f32_32x32x16_bf16 v[192:207], a[88:91], a[200:203], v[192:207]
    ds_read_b64_tr_b16 a[216:217], v22 offset:56320
    ds_read_b64_tr_b16 a[218:219], v22 offset:56576
    s_cmp_eq_u32 s59, 5
    s_cselect_b32 s58, 0, 2147483648
    v_or_b32 v2, s58, v36
    buffer_load_dword v21, v2, s[16:19], 0 offen
    buffer_load_dword v21, v2, s[20:23], 0 offen
    v_mfma_f32_32x32x16_bf16 v[176:191], a[204:207], a[88:91], v[176:191]
    ds_read_b128 a[220:223], v10 offset:736
    s_waitcnt lgkmcnt(3)
    v_mfma_f32_32x32x16_bf16 v[224:239], a[208:211], a[92:95], v[224:239]
    s_waitcnt vmcnt(11)
    s_barrier
    ds_read_b128 a[96:99], v252 offset:0
    ds_read_b64_tr_b16 a[200:201], v23 offset:16384
    ds_read_b64_tr_b16 a[202:203], v23 offset:16640
    v_and_b32 v12, 15, v0
    v_lshlrev_b32 v12, 2, v12
    buffer_load_dword v13, v12, s[40:43], 0 offen sc1
    v_mfma_f32_32x32x16_bf16 v[208:223], a[212:215], a[92:95], v[208:223]
    ds_read_b64_tr_b16 a[204:205], v23 offset:17408
    ds_read_b64_tr_b16 a[206:207], v23 offset:17664
    s_waitcnt lgkmcnt(5)
    v_mfma_f32_32x32x16_bf16 v[192:207], a[92:95], a[216:219], v[192:207]
    ds_read_b64_tr_b16 a[208:209], v23 offset:18432
    ds_read_b64_tr_b16 a[210:211], v23 offset:18688
    s_add_u32 s79, s73, 0
    s_and_b32 s79, s79, 7
    s_lshl_b32 s80, s83, 1
    s_add_u32 m0, s80, 0
    s_mul_i32 s81, s79, 176128
    buffer_load_dwordx4 v18, s[16:19], s81 offen offset:0 lds
    v_mfma_f32_32x32x16_bf16 v[176:191], a[220:223], a[92:95], v[176:191]
    ds_read_b128 a[212:215], v10 offset:768
    s_waitcnt lgkmcnt(3)
    v_mfma_f32_32x32x16_bf16 v[224:239], a[200:203], a[96:99], v[224:239]
    ds_read_b128 a[100:103], v253 offset:0
    ds_read_b64_tr_b16 a[216:217], v23 offset:19456
    ds_read_b64_tr_b16 a[218:219], v23 offset:19712
    buffer_load_dwordx4 v19, s[16:19], s81 offen offset:1024 lds
    v_mfma_f32_32x32x16_bf16 v[208:223], a[204:207], a[96:99], v[208:223]
    ds_read_b64_tr_b16 a[220:221], v23 offset:20480
    ds_read_b64_tr_b16 a[222:223], v23 offset:20736
    s_waitcnt lgkmcnt(5)
    v_mfma_f32_32x32x16_bf16 v[192:207], a[96:99], a[208:211], v[192:207]
    ds_read_b64_tr_b16 a[200:201], v23 offset:21504
    ds_read_b64_tr_b16 a[202:203], v23 offset:21760
    buffer_load_dwordx4 v20, s[16:19], s81 offen offset:2048 lds
    v_mfma_f32_32x32x16_bf16 v[176:191], a[212:215], a[96:99], v[176:191]
    ds_read_b128 a[204:207], v10 offset:800
    s_waitcnt lgkmcnt(3)
    v_mfma_f32_32x32x16_bf16 v[224:239], a[216:219], a[100:103], v[224:239]
    ds_read_b128 a[104:107], v254 offset:0
    ds_read_b64_tr_b16 a[208:209], v23 offset:22528
    ds_read_b64_tr_b16 a[210:211], v23 offset:22784
    s_add_u32 m0, s80, 3072
    s_nop 0
    buffer_load_dwordx4 v18, s[20:23], s81 offen offset:0 lds
    v_mfma_f32_32x32x16_bf16 v[208:223], a[220:223], a[100:103], v[208:223]
    ds_read_b64_tr_b16 a[212:213], v23 offset:23552
    ds_read_b64_tr_b16 a[214:215], v23 offset:23808
    s_waitcnt lgkmcnt(5)
    v_mfma_f32_32x32x16_bf16 v[192:207], a[100:103], a[200:203], v[192:207]
    ds_read_b64_tr_b16 a[216:217], v23 offset:24576
    ds_read_b64_tr_b16 a[218:219], v23 offset:24832
    buffer_load_dwordx4 v19, s[20:23], s81 offen offset:1024 lds
    v_mfma_f32_32x32x16_bf16 v[176:191], a[204:207], a[100:103], v[176:191]
    ds_read_b128 a[220:223], v10 offset:832
    s_waitcnt lgkmcnt(3)
    v_mfma_f32_32x32x16_bf16 v[224:239], a[208:211], a[104:107], v[224:239]
    ds_read_b128 a[108:111], v255 offset:0
    ds_read_b64_tr_b16 a[200:201], v23 offset:25600
    ds_read_b64_tr_b16 a[202:203], v23 offset:25856
    buffer_load_dwordx4 v20, s[20:23], s81 offen offset:2048 lds
    v_mfma_f32_32x32x16_bf16 v[208:223], a[212:215], a[104:107], v[208:223]
    ds_read_b64_tr_b16 a[204:205], v23 offset:26624
    ds_read_b64_tr_b16 a[206:207], v23 offset:26880
    s_waitcnt lgkmcnt(5)
    v_mfma_f32_32x32x16_bf16 v[192:207], a[104:107], a[216:219], v[192:207]
    ds_read_b64_tr_b16 a[208:209], v23 offset:27648
    ds_read_b64_tr_b16 a[210:211], v23 offset:27904
    v_mfma_f32_32x32x16_bf16 v[176:191], a[220:223], a[104:107], v[176:191]
    ds_read_b128 a[212:215], v10 offset:864
    s_waitcnt lgkmcnt(3)
    v_mfma_f32_32x32x16_bf16 v[224:239], a[200:203], a[108:111], v[224:239]
    s_waitcnt vmcnt(9)
    s_barrier
    ds_read_b128 a[112:115], v252 offset:28672
    ds_read_b64_tr_b16 a[216:217], v23 offset:45056
    ds_read_b64_tr_b16 a[218:219], v23 offset:45312
    s_add_u32 s79, s73, 1
    s_and_b32 s79, s79, 7
    s_lshl_b32 s80, s83, 1
    s_add_u32 m0, s80, 24576
    s_mul_i32 s81, s79, 176128
    buffer_load_dwordx4 v18, s[16:19], s81 offen offset:0 lds
    v_mfma_f32_32x32x16_bf16 v[208:223], a[204:207], a[108:111], v[208:223]
    ds_read_b64_tr_b16 a[220:221], v23 offset:46080
    ds_read_b64_tr_b16 a[222:223], v23 offset:46336
    s_waitcnt lgkmcnt(5)
    v_mfma_f32_32x32x16_bf16 v[192:207], a[108:111], a[208:211], v[192:207]
    ds_read_b64_tr_b16 a[200:201], v23 offset:47104
    ds_read_b64_tr_b16 a[202:203], v23 offset:47360
    buffer_load_dwordx4 v19, s[16:19], s81 offen offset:1024 lds
    v_mfma_f32_32x32x16_bf16 v[176:191], a[212:215], a[108:111], v[176:191]
    ds_read_b128 a[204:207], v10 offset:896
    s_waitcnt lgkmcnt(3)
    v_mfma_f32_32x32x16_bf16 v[224:239], a[216:219], a[112:115], v[224:239]
    ds_read_b128 a[116:119], v253 offset:28672
    ds_read_b64_tr_b16 a[208:209], v23 offset:48128
    ds_read_b64_tr_b16 a[210:211], v23 offset:48384
    buffer_load_dwordx4 v20, s[16:19], s81 offen offset:2048 lds
    v_mfma_f32_32x32x16_bf16 v[208:223], a[220:223], a[112:115], v[208:223]
    ds_read_b64_tr_b16 a[212:213], v23 offset:49152
    ds_read_b64_tr_b16 a[214:215], v23 offset:49408
    s_waitcnt lgkmcnt(5)
    v_mfma_f32_32x32x16_bf16 v[192:207], a[112:115], a[200:203], v[192:207]
    ds_read_b64_tr_b16 a[216:217], v23 offset:50176
    ds_read_b64_tr_b16 a[218:219], v23 offset:50432
    s_add_u32 m0, s80, 27648
    s_nop 0
    buffer_load_dwordx4 v18, s[20:23], s81 offen offset:0 lds
    v_mfma_f32_32x32x16_bf16 v[176:191], a[204:207], a[112:115], v[176:191]
    ds_read_b128 a[220:223], v10 offset:928
    s_waitcnt lgkmcnt(3)
    v_mfma_f32_32x32x16_bf16 v[224:239], a[208:211], a[116:119], v[224:239]
    ds_read_b128 a[120:123], v254 offset:28672
    ds_read_b64_tr_b16 a[200:201], v23 offset:51200
    ds_read_b64_tr_b16 a[202:203], v23 offset:51456
    buffer_load_dwordx4 v19, s[20:23], s81 offen offset:1024 lds
    v_mfma_f32_32x32x16_bf16 v[208:223], a[212:215], a[116:119], v[208:223]
    ds_read_b64_tr_b16 a[204:205], v23 offset:52224
    ds_read_b64_tr_b16 a[206:207], v23 offset:52480
L_pad_0:
    s_cbranch_execz L_pad_4
    s_waitcnt lgkmcnt(5)
    v_mfma_f32_32x32x16_bf16 v[192:207], a[116:119], a[216:219], v[192:207]
    ds_read_b64_tr_b16 a[208:209], v23 offset:53248
    ds_read_b64_tr_b16 a[210:211], v23 offset:53504
    buffer_load_dwordx4 v20, s[20:23], s81 offen offset:2048 lds
    v_mfma_f32_32x32x16_bf16 v[176:191], a[220:223], a[116:119], v[176:191]
    ds_read_b128 a[212:215], v10 offset:960
    s_waitcnt lgkmcnt(3)
    v_mfma_f32_32x32x16_bf16 v[224:239], a[200:203], a[120:123], v[224:239]
    ds_read_b128 a[124:127], v255 offset:28672
    ds_read_b64_tr_b16 a[216:217], v23 offset:54272
    ds_read_b64_tr_b16 a[218:219], v23 offset:54528
    v_mfma_f32_32x32x16_bf16 v[208:223], a[204:207], a[120:123], v[208:223]
    ds_read_b64_tr_b16 a[220:221], v23 offset:55296
    ds_read_b64_tr_b16 a[222:223], v23 offset:55552
    s_waitcnt lgkmcnt(5)
    v_mfma_f32_32x32x16_bf16 v[192:207], a[120:123], a[208:211], v[192:207]
    ds_read_b64_tr_b16 a[200:201], v23 offset:56320
    ds_read_b64_tr_b16 a[202:203], v23 offset:56576
    v_mfma_f32_32x32x16_bf16 v[176:191], a[212:215], a[120:123], v[176:191]
    ds_read_b128 a[204:207], v10 offset:992
    s_waitcnt lgkmcnt(3)
    v_mfma_f32_32x32x16_bf16 v[224:239], a[216:219], a[124:127], v[224:239]
    s_waitcnt vmcnt(6)
    s_barrier
    ds_read_b64_tr_b16 a[208:209], v22 offset:0
    ds_read_b64_tr_b16 a[210:211], v22 offset:256
    s_add_u32 s79, s73, 2
    v_mfma_f32_32x32x16_bf16 v[208:223], a[220:223], a[124:127], v[208:223]
    ds_read_b64_tr_b16 a[212:213], v22 offset:1024
    ds_read_b64_tr_b16 a[214:215], v22 offset:1280
    s_waitcnt lgkmcnt(4)
    v_mfma_f32_32x32x16_bf16 v[192:207], a[124:127], a[200:203], v[192:207]
    ds_read_b64_tr_b16 a[216:217], v22 offset:2048
    ds_read_b64_tr_b16 a[218:219], v22 offset:2304
    s_and_b32 s79, s79, 7
    v_mfma_f32_32x32x16_bf16 v[176:191], a[204:207], a[124:127], v[176:191]
    ds_read_b64_tr_b16 a[220:221], v22 offset:3072
    ds_read_b64_tr_b16 a[222:223], v22 offset:3328
    s_waitcnt lgkmcnt(4)
    v_mfma_f32_32x32x16_bf16 v[160:175], a[208:211], a[0:3], 0
    ds_read_b64_tr_b16 a[200:201], v22 offset:4096
    ds_read_b64_tr_b16 a[202:203], v22 offset:4352
    s_lshl_b32 s80, s83, 1
    s_add_u32 m0, s80, 49152
    s_mul_i32 s81, s79, 176128
    v_mfma_f32_32x32x16_bf16 v[144:159], a[212:215], a[0:3], 0
    ds_read_b64_tr_b16 a[204:205], v22 offset:5120
    ds_read_b64_tr_b16 a[206:207], v22 offset:5376
    buffer_load_dwordx4 v18, s[16:19], s81 offen offset:0 lds
    s_waitcnt lgkmcnt(4)
    v_mfma_f32_32x32x16_bf16 v[128:143], a[216:219], a[0:3], 0
    ds_read_b64_tr_b16 a[208:209], v22 offset:6144
    ds_read_b64_tr_b16 a[210:211], v22 offset:6400
    s_lshl_b32 s4, s72, 6
    s_add_u32 s4, s4, s84
    s_lshl_b32 s4, s4, 12
    v_mfma_f32_32x32x16_bf16 v[112:127], a[220:223], a[0:3], 0
    ds_read_b64_tr_b16 a[212:213], v22 offset:7168
    ds_read_b64_tr_b16 a[214:215], v22 offset:7424
    v_add_u32 v5, s4, v11
    s_add_u32 s4, s82, 147456
    v_add_u32 v10, s4, v11
    s_waitcnt lgkmcnt(4)
    v_mfma_f32_32x32x16_bf16 v[96:111], a[200:203], a[0:3], 0
    ds_read_b64_tr_b16 a[216:217], v22 offset:8192
    ds_read_b64_tr_b16 a[218:219], v22 offset:8448
    buffer_load_dwordx4 v19, s[16:19], s81 offen offset:1024 lds
    v_cvt_pk_bf16_f32 v76, v208, v209
    v_mfma_f32_32x32x16_bf16 v[80:95], a[204:207], a[0:3], 0
    ds_read_b64_tr_b16 a[220:221], v22 offset:9216
    ds_read_b64_tr_b16 a[222:223], v22 offset:9472
    v_cvt_pk_bf16_f32 v77, v210, v211
    v_cvt_pk_bf16_f32 v78, v212, v213
    v_cvt_pk_bf16_f32 v79, v214, v215
    s_waitcnt lgkmcnt(4)
    v_mfma_f32_32x32x16_bf16 v[160:175], a[208:211], a[4:7], v[160:175]
    ds_read_b64_tr_b16 a[200:201], v22 offset:10240
    ds_read_b64_tr_b16 a[202:203], v22 offset:10496
    buffer_store_dwordx4 v[76:79], v5, s[32:35], 0 offen offset:0 sc1
    v_mfma_f32_32x32x16_bf16 v[144:159], a[212:215], a[4:7], v[144:159]
    ds_read_b64_tr_b16 a[204:205], v22 offset:11264
    ds_read_b64_tr_b16 a[206:207], v22 offset:11520
    buffer_load_dwordx4 v20, s[16:19], s81 offen offset:2048 lds
    s_waitcnt lgkmcnt(4)
    v_mfma_f32_32x32x16_bf16 v[128:143], a[216:219], a[4:7], v[128:143]
    ds_read_b64_tr_b16 a[208:209], v22 offset:12288
    ds_read_b64_tr_b16 a[210:211], v22 offset:12544
    s_add_u32 m0, s80, 52224
    v_cvt_pk_bf16_f32 v72, v216, v217
    v_cvt_pk_bf16_f32 v73, v218, v219
    v_mfma_f32_32x32x16_bf16 v[112:127], a[220:223], a[4:7], v[112:127]
    ds_read_b64_tr_b16 a[212:213], v22 offset:13312
    ds_read_b64_tr_b16 a[214:215], v22 offset:13568
    v_cvt_pk_bf16_f32 v74, v220, v221
    v_cvt_pk_bf16_f32 v75, v222, v223
    s_waitcnt lgkmcnt(4)
    v_mfma_f32_32x32x16_bf16 v[96:111], a[200:203], a[4:7], v[96:111]
    ds_read_b64_tr_b16 a[216:217], v22 offset:14336
    ds_read_b64_tr_b16 a[218:219], v22 offset:14592
    buffer_load_dwordx4 v18, s[20:23], s81 offen offset:0 lds
    buffer_store_dwordx4 v[72:75], v5, s[32:35], 0 offen offset:1024 sc1
    v_mfma_f32_32x32x16_bf16 v[80:95], a[204:207], a[4:7], v[80:95]
    ds_read_b64_tr_b16 a[220:221], v22 offset:15360
    ds_read_b64_tr_b16 a[222:223], v22 offset:15616
    v_cvt_pk_bf16_f32 v68, v192, v193
    v_cvt_pk_bf16_f32 v69, v194, v195
    v_cvt_pk_bf16_f32 v70, v196, v197
    s_waitcnt lgkmcnt(4)
    v_mfma_f32_32x32x16_bf16 v[160:175], a[208:211], a[8:11], v[160:175]
    ds_read_b64_tr_b16 a[200:201], v22 offset:16384
    ds_read_b64_tr_b16 a[202:203], v22 offset:16640
    v_cvt_pk_bf16_f32 v71, v198, v199
    v_mfma_f32_32x32x16_bf16 v[144:159], a[212:215], a[8:11], v[144:159]
    ds_read_b64_tr_b16 a[204:205], v22 offset:17408
    ds_read_b64_tr_b16 a[206:207], v22 offset:17664
    buffer_load_dwordx4 v19, s[20:23], s81 offen offset:1024 lds
    s_waitcnt lgkmcnt(4)
    v_mfma_f32_32x32x16_bf16 v[128:143], a[216:219], a[8:11], v[128:143]
    ds_read_b64_tr_b16 a[208:209], v22 offset:18432
    ds_read_b64_tr_b16 a[210:211], v22 offset:18688
    buffer_store_dwordx4 v[68:71], v5, s[32:35], 0 offen offset:2048 sc1
    v_mfma_f32_32x32x16_bf16 v[112:127], a[220:223], a[8:11], v[112:127]
    ds_read_b64_tr_b16 a[212:213], v22 offset:19456
    ds_read_b64_tr_b16 a[214:215], v22 offset:19712
    v_cvt_pk_bf16_f32 v64, v200, v201
    v_cvt_pk_bf16_f32 v65, v202, v203
    v_cvt_pk_bf16_f32 v66, v204, v205
    s_waitcnt lgkmcnt(4)
    v_mfma_f32_32x32x16_bf16 v[96:111], a[200:203], a[8:11], v[96:111]
    ds_read_b64_tr_b16 a[216:217], v22 offset:20480
    ds_read_b64_tr_b16 a[218:219], v22 offset:20736
    buffer_load_dwordx4 v20, s[20:23], s81 offen offset:2048 lds
    v_cvt_pk_bf16_f32 v67, v206, v207
    v_mfma_f32_32x32x16_bf16 v[80:95], a[204:207], a[8:11], v[80:95]
    ds_read_b64_tr_b16 a[220:221], v22 offset:21504
    ds_read_b64_tr_b16 a[222:223], v22 offset:21760
    buffer_store_dwordx4 v[64:67], v5, s[32:35], 0 offen offset:3072 sc1
    s_waitcnt lgkmcnt(4)
    v_mfma_f32_32x32x16_bf16 v[160:175], a[208:211], a[12:15], v[160:175]
    ds_read_b64_tr_b16 a[200:201], v22 offset:22528
    ds_read_b64_tr_b16 a[202:203], v22 offset:22784
    s_mov_b32 s4, 0x3eb8aa3b
    ds_write_b128 v10, v[76:79] offset:0
    v_mul_f32 v224, s4, v224
    v_mfma_f32_32x32x16_bf16 v[144:159], a[212:215], a[12:15], v[144:159]
    ds_read_b64_tr_b16 a[204:205], v22 offset:23552
    ds_read_b64_tr_b16 a[206:207], v22 offset:23808
    v_mul_f32 v225, s4, v225
    v_mul_f32 v226, s4, v226
    v_mul_f32 v227, s4, v227
    s_waitcnt lgkmcnt(5)
    v_mfma_f32_32x32x16_bf16 v[128:143], a[216:219], a[12:15], v[128:143]
    s_waitcnt vmcnt(10)
    s_barrier
    ds_read_b64_tr_b16 a[208:209], v22 offset:24576
    ds_read_b64_tr_b16 a[210:211], v22 offset:24832
    s_add_u32 s79, s73, 3
    ds_write_b128 v10, v[72:75] offset:1024
    v_mfma_f32_32x32x16_bf16 v[112:127], a[220:223], a[12:15], v[112:127]
    ds_read_b64_tr_b16 a[212:213], v22 offset:25600
    ds_read_b64_tr_b16 a[214:215], v22 offset:25856
    s_and_b32 s79, s79, 7
    s_lshl_b32 s80, s83, 1
    s_add_u32 m0, s80, 73728
    s_waitcnt lgkmcnt(5)
    v_mfma_f32_32x32x16_bf16 v[96:111], a[200:203], a[12:15], v[96:111]
    ds_read_b64_tr_b16 a[216:217], v22 offset:26624
    ds_read_b64_tr_b16 a[218:219], v22 offset:26880
    s_mul_i32 s81, s79, 176128
    v_mul_f32 v228, s4, v228
    v_mul_f32 v229, s4, v229
    v_mfma_f32_32x32x16_bf16 v[80:95], a[204:207], a[12:15], v[80:95]
    ds_read_b64_tr_b16 a[220:221], v22 offset:27648
    ds_read_b64_tr_b16 a[222:223], v22 offset:27904
    buffer_load_dwordx4 v18, s[16:19], s81 offen offset:0 lds
    s_waitcnt lgkmcnt(4)
    v_mfma_f32_32x32x16_bf16 v[160:175], a[208:211], a[16:19], v[160:175]
    ds_read_b64_tr_b16 a[200:201], v22 offset:28672
    ds_read_b64_tr_b16 a[202:203], v22 offset:28928
    v_mul_f32 v230, s4, v230
    v_mul_f32 v231, s4, v231
    ds_write_b128 v10, v[68:71] offset:2048
    v_mfma_f32_32x32x16_bf16 v[144:159], a[212:215], a[16:19], v[144:159]
    ds_read_b64_tr_b16 a[204:205], v22 offset:29696
    ds_read_b64_tr_b16 a[206:207], v22 offset:29952
    v_mul_f32 v232, s4, v232
    v_mul_f32 v233, s4, v233
    v_mul_f32 v234, s4, v234
    s_waitcnt lgkmcnt(5)
    v_mfma_f32_32x32x16_bf16 v[128:143], a[216:219], a[16:19], v[128:143]
    ds_read_b64_tr_b16 a[208:209], v22 offset:30720
    ds_read_b64_tr_b16 a[210:211], v22 offset:30976
    buffer_load_dwordx4 v19, s[16:19], s81 offen offset:1024 lds
    v_mul_f32 v235, s4, v235
    v_mfma_f32_32x32x16_bf16 v[112:127], a[220:223], a[16:19], v[112:127]
    ds_read_b64_tr_b16 a[212:213], v22 offset:31744
    ds_read_b64_tr_b16 a[214:215], v22 offset:32000
    ds_write_b128 v10, v[64:67] offset:3072
    v_mul_f32 v236, s4, v236
    v_mul_f32 v237, s4, v237
    s_waitcnt lgkmcnt(5)
    v_mfma_f32_32x32x16_bf16 v[96:111], a[200:203], a[16:19], v[96:111]
    ds_read_b64_tr_b16 a[216:217], v22 offset:32768
    ds_read_b64_tr_b16 a[218:219], v22 offset:33024
    v_mul_f32 v238, s4, v238
    v_mul_f32 v239, s4, v239
    v_cvt_pk_bf16_f32 v176, v176, v176
    v_mfma_f32_32x32x16_bf16 v[80:95], a[204:207], a[16:19], v[80:95]
    ds_read_b64_tr_b16 a[220:221], v22 offset:33792
    ds_read_b64_tr_b16 a[222:223], v22 offset:34048
    buffer_load_dwordx4 v20, s[16:19], s81 offen offset:2048 lds
    s_waitcnt lgkmcnt(5)
    v_mfma_f32_32x32x16_bf16 v[160:175], a[208:211], a[20:23], v[160:175]
    ds_read_b64_tr_b16 a[200:201], v22 offset:34816
    ds_read_b64_tr_b16 a[202:203], v22 offset:35072
    s_add_u32 m0, s80, 76800
    v_and_b32 v176, 0xffff0000, v176
    v_mul_f32 v176, 0xbfb8aa3b, v176
    v_mfma_f32_32x32x16_bf16 v[144:159], a[212:215], a[20:23], v[144:159]
    ds_read_b64_tr_b16 a[204:205], v22 offset:35840
    ds_read_b64_tr_b16 a[206:207], v22 offset:36096
    v_exp_f32 v176, v176
    v_cvt_pk_bf16_f32 v248, v224, v225
    s_waitcnt lgkmcnt(4)
    v_mfma_f32_32x32x16_bf16 v[128:143], a[216:219], a[20:23], v[128:143]
    ds_read_b64_tr_b16 a[208:209], v22 offset:36864
    ds_read_b64_tr_b16 a[210:211], v22 offset:37120
    buffer_load_dwordx4 v18, s[20:23], s81 offen offset:0 lds
    v_cvt_pk_bf16_f32 v249, v226, v227
    v_mfma_f32_32x32x16_bf16 v[112:127], a[220:223], a[20:23], v[112:127]
    ds_read_b64_tr_b16 a[212:213], v22 offset:37888
    ds_read_b64_tr_b16 a[214:215], v22 offset:38144
    v_cvt_pk_bf16_f32 v250, v228, v229
    v_cvt_pk_bf16_f32 v251, v230, v231
    v_add_f32 v176, 1.0, v176
    s_waitcnt lgkmcnt(4)
    v_mfma_f32_32x32x16_bf16 v[96:111], a[200:203], a[20:23], v[96:111]
    ds_read_b64_tr_b16 a[216:217], v22 offset:38912
    ds_read_b64_tr_b16 a[218:219], v22 offset:39168
    v_rcp_f32 v176, v176
    v_cvt_pk_bf16_f32 v252, v232, v233
    v_mfma_f32_32x32x16_bf16 v[80:95], a[204:207], a[20:23], v[80:95]
    ds_read_b64_tr_b16 a[220:221], v22 offset:39936
    ds_read_b64_tr_b16 a[222:223], v22 offset:40192
    buffer_load_dwordx4 v19, s[20:23], s81 offen offset:1024 lds
    s_waitcnt lgkmcnt(4)
    v_mfma_f32_32x32x16_bf16 v[160:175], a[208:211], a[24:27], v[160:175]
    ds_read_b64_tr_b16 a[200:201], v22 offset:40960
    ds_read_b64_tr_b16 a[202:203], v22 offset:41216
    v_cvt_pk_bf16_f32 v253, v234, v235
    v_cvt_pk_bf16_f32 v254, v236, v237
    v_cvt_pk_bf16_f32 v255, v238, v239
    v_mfma_f32_32x32x16_bf16 v[144:159], a[212:215], a[24:27], v[144:159]
    ds_read_b64_tr_b16 a[204:205], v22 offset:41984
    ds_read_b64_tr_b16 a[206:207], v22 offset:42240
    v_cvt_pk_bf16_f32 v176, v176, v176
    v_and_b32 v6, 0xffff0000, v176
    v_sub_f32 v176, 1.0, v6
    s_waitcnt lgkmcnt(4)
    v_mfma_f32_32x32x16_bf16 v[128:143], a[216:219], a[24:27], v[128:143]
    ds_read_b64_tr_b16 a[208:209], v22 offset:43008
    ds_read_b64_tr_b16 a[210:211], v22 offset:43264
    buffer_load_dwordx4 v20, s[20:23], s81 offen offset:2048 lds
    v_cvt_pk_bf16_f32 v176, v176, v176
    v_mfma_f32_32x32x16_bf16 v[112:127], a[220:223], a[24:27], v[112:127]
    ds_read_b64_tr_b16 a[212:213], v22 offset:44032
    ds_read_b64_tr_b16 a[214:215], v22 offset:44288
    v_and_b32 v176, 0xffff0000, v176
    v_rcp_f32 v176, v176
    s_waitcnt lgkmcnt(4)
    v_mfma_f32_32x32x16_bf16 v[96:111], a[200:203], a[24:27], v[96:111]
    ds_read_b64_tr_b16 a[216:217], v22 offset:45056
    ds_read_b64_tr_b16 a[218:219], v22 offset:45312
    v_min_f32 v8, 0x7b800000, v176
    v_mov_b32 v9, v8
    s_add_u32 s4, s82, 114688
    v_mfma_f32_32x32x16_bf16 v[80:95], a[204:207], a[24:27], v[80:95]
    ds_read_b64_tr_b16 a[220:221], v22 offset:46080
    ds_read_b64_tr_b16 a[222:223], v22 offset:46336
    v_add_u32 v5, s4, v11
    v_and_b32 v10, 31, v0
    v_lshrrev_b32 v14, 5, v0
    s_waitcnt lgkmcnt(4)
    v_mfma_f32_32x32x16_bf16 v[160:175], a[208:211], a[28:31], v[160:175]
    ds_read_b64_tr_b16 a[200:201], v22 offset:47104
    ds_read_b64_tr_b16 a[202:203], v22 offset:47360
    v_lshlrev_b32 v14, 2, v14
    v_sub_u32 v10, v10, v14
    v_mov_b32 v14, 0xf149f2ca
    v_mfma_f32_32x32x16_bf16 v[144:159], a[212:215], a[28:31], v[144:159]
    ds_read_b64_tr_b16 a[204:205], v22 offset:48128
    ds_read_b64_tr_b16 a[206:207], v22 offset:48384
    v_mov_b32 v15, 0
    v_cmp_le_i32 s[4:5], 0, v10
    v_mov_b32 v200, 0x3f803f80
    s_waitcnt lgkmcnt(4)
    v_mfma_f32_32x32x16_bf16 v[128:143], a[216:219], a[28:31], v[128:143]
    s_waitcnt vmcnt(7)
    s_barrier
    ds_read_b64_tr_b16 a[208:209], v24 offset:0
    ds_read_b64_tr_b16 a[210:211], v24 offset:256
    s_waitcnt vmcnt(6)
    v_cmp_ne_u32 vcc, 1, v13
    s_mov_b32 s93, 0
    s_cbranch_vccz L_init_ok
L_init_retry:
    buffer_load_dword v13, v12, s[40:43], 0 offen sc1
    s_add_u32 s93, s93, 1
    s_cmp_ge_u32 s93, 0x40000
    s_waitcnt vmcnt(0)
    v_cmp_ne_u32 vcc, 1, v13
    s_cbranch_scc1 L_init_ok
    s_cbranch_vccnz L_init_retry
L_init_ok:
    v_mov_b32 v1, s48
    s_mov_b64 exec, 1
    buffer_atomic_add v16, v1, s[32:35], 0 offen sc1
    s_mov_b64 exec, -1
    v_mov_b32 v12, s49
    v_cndmask_b32 v224, v14, v15, s[4:5]
    v_mfma_f32_32x32x16_bf16 v[112:127], a[220:223], a[28:31], v[112:127]
    ds_read_b64_tr_b16 a[212:213], v24 offset:1024
    ds_read_b64_tr_b16 a[214:215], v24 offset:1280
    s_add_u32 s79, s73, 4
    s_and_b32 s79, s79, 7
    s_lshl_b32 s80, s83, 1
    s_waitcnt lgkmcnt(4)
    v_mfma_f32_32x32x16_bf16 v[96:111], a[200:203], a[28:31], v[96:111]
    ds_read_b64_tr_b16 a[216:217], v24 offset:2048
    ds_read_b64_tr_b16 a[218:219], v24 offset:2304
    s_add_u32 m0, s80, 0
    s_mul_i32 s81, s79, 176128
    v_cndmask_b32 v208, v15, v14, s[4:5]
    v_mfma_f32_32x32x16_bf16 v[80:95], a[204:207], a[28:31], v[80:95]
    ds_read_b64_tr_b16 a[220:221], v24 offset:3072
    ds_read_b64_tr_b16 a[222:223], v24 offset:3328
    buffer_load_dwordx4 v18, s[16:19], s81 offen offset:0 lds
    s_waitcnt lgkmcnt(4)
    v_mfma_f32_32x32x16_bf16 v[160:175], a[208:211], a[32:35], v[160:175]
    ds_read_b64_tr_b16 a[200:201], v24 offset:4096
    ds_read_b64_tr_b16 a[202:203], v24 offset:4352
    v_cmp_le_i32 s[4:5], 1, v10
    v_mov_b32 v201, 0x3f803f80
    s_nop 0
    v_cndmask_b32 v225, v14, v15, s[4:5]
    v_mfma_f32_32x32x16_bf16 v[144:159], a[212:215], a[32:35], v[144:159]
    ds_read_b64_tr_b16 a[204:205], v24 offset:5120
    ds_read_b64_tr_b16 a[206:207], v24 offset:5376
    v_cndmask_b32 v209, v15, v14, s[4:5]
    v_cmp_le_i32 s[4:5], 2, v10
    v_mov_b32 v202, 0x3f803f80
    s_waitcnt lgkmcnt(4)
    v_mfma_f32_32x32x16_bf16 v[128:143], a[216:219], a[32:35], v[128:143]
    ds_read_b64_tr_b16 a[208:209], v24 offset:6144
    ds_read_b64_tr_b16 a[210:211], v24 offset:6400
    buffer_load_dwordx4 v19, s[16:19], s81 offen offset:1024 lds
    v_cndmask_b32 v226, v14, v15, s[4:5]
    v_mfma_f32_32x32x16_bf16 v[112:127], a[220:223], a[32:35], v[112:127]
    ds_read_b64_tr_b16 a[212:213], v24 offset:7168
    ds_read_b64_tr_b16 a[214:215], v24 offset:7424
    v_cndmask_b32 v210, v15, v14, s[4:5]
    v_cmp_le_i32 s[4:5], 3, v10
    v_mov_b32 v203, 0x3f803f80
    s_waitcnt lgkmcnt(4)
    v_mfma_f32_32x32x16_bf16 v[96:111], a[200:203], a[32:35], v[96:111]
    ds_read_b64_tr_b16 a[216:217], v24 offset:8192
    ds_read_b64_tr_b16 a[218:219], v24 offset:8448
    v_cndmask_b32 v227, v14, v15, s[4:5]
    v_cndmask_b32 v211, v15, v14, s[4:5]
    v_cmp_le_i32 s[4:5], 8, v10
    v_mfma_f32_32x32x16_bf16 v[80:95], a[204:207], a[32:35], v[80:95]
    ds_read_b64_tr_b16 a[220:221], v24 offset:9216
    ds_read_b64_tr_b16 a[222:223], v24 offset:9472
    buffer_load_dwordx4 v20, s[16:19], s81 offen offset:2048 lds
    s_waitcnt lgkmcnt(4)
    v_mfma_f32_32x32x16_bf16 v[160:175], a[208:211], a[36:39], v[160:175]
    ds_read_b64_tr_b16 a[200:201], v24 offset:10240
    ds_read_b64_tr_b16 a[202:203], v24 offset:10496
    s_add_u32 m0, s80, 3072
    v_mov_b32 v204, 0x3f803f80
    v_cndmask_b32 v228, v14, v15, s[4:5]
    v_mfma_f32_32x32x16_bf16 v[144:159], a[212:215], a[36:39], v[144:159]
    ds_read_b64_tr_b16 a[204:205], v24 offset:11264
    ds_read_b64_tr_b16 a[206:207], v24 offset:11520
    v_cndmask_b32 v212, v15, v14, s[4:5]
    v_cmp_le_i32 s[4:5], 9, v10
    v_mov_b32 v205, 0x3f803f80
    s_waitcnt lgkmcnt(4)
    v_mfma_f32_32x32x16_bf16 v[128:143], a[216:219], a[36:39], v[128:143]
    ds_read_b64_tr_b16 a[208:209], v24 offset:12288
    ds_read_b64_tr_b16 a[210:211], v24 offset:12544
    buffer_load_dwordx4 v18, s[20:23], s81 offen offset:0 lds
    v_cndmask_b32 v229, v14, v15, s[4:5]
    v_mfma_f32_32x32x16_bf16 v[112:127], a[220:223], a[36:39], v[112:127]
    ds_read_b64_tr_b16 a[212:213], v24 offset:13312
    ds_read_b64_tr_b16 a[214:215], v24 offset:13568
    v_cndmask_b32 v213, v15, v14, s[4:5]
    v_cmp_le_i32 s[4:5], 10, v10
    v_mov_b32 v206, 0x3f803f80
    s_waitcnt lgkmcnt(4)
    v_mfma_f32_32x32x16_bf16 v[96:111], a[200:203], a[36:39], v[96:111]
    ds_read_b64_tr_b16 a[216:217], v24 offset:14336
    ds_read_b64_tr_b16 a[218:219], v24 offset:14592
    v_cndmask_b32 v230, v14, v15, s[4:5]
    v_cndmask_b32 v214, v15, v14, s[4:5]
    v_cmp_le_i32 s[4:5], 11, v10
    v_mfma_f32_32x32x16_bf16 v[80:95], a[204:207], a[36:39], v[80:95]
    ds_read_b64_tr_b16 a[220:221], v24 offset:15360
    ds_read_b64_tr_b16 a[222:223], v24 offset:15616
    buffer_load_dwordx4 v19, s[20:23], s81 offen offset:1024 lds
    s_waitcnt lgkmcnt(4)
    v_mfma_f32_32x32x16_bf16 v[160:175], a[208:211], a[40:43], v[160:175]
    ds_read_b64_tr_b16 a[200:201], v24 offset:16384
    ds_read_b64_tr_b16 a[202:203], v24 offset:16640
    v_mov_b32 v207, 0x3f803f80
    v_cndmask_b32 v231, v14, v15, s[4:5]
    v_cndmask_b32 v215, v15, v14, s[4:5]
    v_mfma_f32_32x32x16_bf16 v[144:159], a[212:215], a[40:43], v[144:159]
    ds_read_b64_tr_b16 a[204:205], v24 offset:17408
    ds_read_b64_tr_b16 a[206:207], v24 offset:17664
    v_cmp_le_i32 s[4:5], 16, v10
    v_mov_b32 v192, 0x3f803f80
    s_nop 0
    v_cndmask_b32 v232, v14, v15, s[4:5]
    s_waitcnt lgkmcnt(4)
    v_mfma_f32_32x32x16_bf16 v[128:143], a[216:219], a[40:43], v[128:143]
    ds_read_b64_tr_b16 a[208:209], v24 offset:18432
    ds_read_b64_tr_b16 a[210:211], v24 offset:18688
    buffer_load_dwordx4 v20, s[20:23], s81 offen offset:2048 lds
    v_cndmask_b32 v216, v15, v14, s[4:5]
    v_mfma_f32_32x32x16_bf16 v[112:127], a[220:223], a[40:43], v[112:127]
    ds_read_b64_tr_b16 a[212:213], v24 offset:19456
    ds_read_b64_tr_b16 a[214:215], v24 offset:19712
    s_cmp_eq_u32 s62, 10
    s_cselect_b32 s58, 0, 2147483648
    v_or_b32 v2, s58, v37
    v_or_b32 v3, s58, v38
    buffer_load_dword v21, v2, s[24:27], 0 offen
    buffer_load_dword v21, v3, s[28:31], 0 offen
    s_waitcnt lgkmcnt(4)
    v_mfma_f32_32x32x16_bf16 v[96:111], a[200:203], a[40:43], v[96:111]
    ds_read_b64_tr_b16 a[216:217], v24 offset:20480
    ds_read_b64_tr_b16 a[218:219], v24 offset:20736
    v_cmp_le_i32 s[4:5], 17, v10
    v_mov_b32 v193, 0x3f803f80
    s_nop 0
    v_cndmask_b32 v233, v14, v15, s[4:5]
    v_mfma_f32_32x32x16_bf16 v[80:95], a[204:207], a[40:43], v[80:95]
    ds_read_b64_tr_b16 a[220:221], v24 offset:21504
    ds_read_b64_tr_b16 a[222:223], v24 offset:21760
    v_cndmask_b32 v217, v15, v14, s[4:5]
    v_cmp_le_i32 s[4:5], 18, v10
    v_mov_b32 v194, 0x3f803f80
    s_waitcnt lgkmcnt(4)
    v_mfma_f32_32x32x16_bf16 v[160:175], a[208:211], a[44:47], v[160:175]
    ds_read_b64_tr_b16 a[200:201], v24 offset:22528
    ds_read_b64_tr_b16 a[202:203], v24 offset:22784
    v_cndmask_b32 v234, v14, v15, s[4:5]
    v_cndmask_b32 v218, v15, v14, s[4:5]
    v_cmp_le_i32 s[4:5], 19, v10
    v_mfma_f32_32x32x16_bf16 v[144:159], a[212:215], a[44:47], v[144:159]
    ds_read_b64_tr_b16 a[204:205], v24 offset:23552
    ds_read_b64_tr_b16 a[206:207], v24 offset:23808
    v_mov_b32 v195, 0x3f803f80
    v_cndmask_b32 v235, v14, v15, s[4:5]
    v_cndmask_b32 v219, v15, v14, s[4:5]
    s_waitcnt lgkmcnt(4)
    v_mfma_f32_32x32x16_bf16 v[128:143], a[216:219], a[44:47], v[128:143]
    s_waitcnt vmcnt(9)
    s_barrier
    ds_read_b64_tr_b16 a[208:209], v24 offset:24576
    ds_read_b64_tr_b16 a[210:211], v24 offset:24832
    s_add_u32 s79, s73, 5
    v_cmp_le_i32 s[4:5], 24, v10
    v_mfma_f32_32x32x16_bf16 v[112:127], a[220:223], a[44:47], v[112:127]
    ds_read_b64_tr_b16 a[212:213], v24 offset:25600
    ds_read_b64_tr_b16 a[214:215], v24 offset:25856
    s_and_b32 s79, s79, 7
    s_lshl_b32 s80, s83, 1
    s_add_u32 m0, s80, 24576
    s_waitcnt lgkmcnt(4)
    v_mfma_f32_32x32x16_bf16 v[96:111], a[200:203], a[44:47], v[96:111]
    ds_read_b64_tr_b16 a[216:217], v24 offset:26624
    ds_read_b64_tr_b16 a[218:219], v24 offset:26880
    s_mul_i32 s81, s79, 176128
    v_mov_b32 v196, 0x3f803f80
    v_cndmask_b32 v236, v14, v15, s[4:5]
    v_mfma_f32_32x32x16_bf16 v[80:95], a[204:207], a[44:47], v[80:95]
    ds_read_b64_tr_b16 a[220:221], v24 offset:27648
    ds_read_b64_tr_b16 a[222:223], v24 offset:27904
    buffer_load_dwordx4 v18, s[16:19], s81 offen offset:0 lds
    s_waitcnt lgkmcnt(4)
    v_mfma_f32_32x32x16_bf16 v[160:175], a[208:211], a[48:51], v[160:175]
    ds_read_b64_tr_b16 a[200:201], v24 offset:28672
    ds_read_b64_tr_b16 a[202:203], v24 offset:28928
    v_cndmask_b32 v220, v15, v14, s[4:5]
    v_cmp_le_i32 s[4:5], 25, v10
    v_mov_b32 v197, 0x3f803f80
    v_mfma_f32_32x32x16_bf16 v[144:159], a[212:215], a[48:51], v[144:159]
    ds_read_b64_tr_b16 a[204:205], v24 offset:29696
    ds_read_b64_tr_b16 a[206:207], v24 offset:29952
    v_cndmask_b32 v237, v14, v15, s[4:5]
    v_cndmask_b32 v221, v15, v14, s[4:5]
    v_cmp_le_i32 s[4:5], 26, v10
    s_waitcnt lgkmcnt(4)
    v_mfma_f32_32x32x16_bf16 v[128:143], a[216:219], a[48:51], v[128:143]
    ds_read_b64_tr_b16 a[208:209], v24 offset:30720
    ds_read_b64_tr_b16 a[210:211], v24 offset:30976
    buffer_load_dwordx4 v19, s[16:19], s81 offen offset:1024 lds
    v_mov_b32 v198, 0x3f803f80
    v_mfma_f32_32x32x16_bf16 v[112:127], a[220:223], a[48:51], v[112:127]
    ds_read_b64_tr_b16 a[212:213], v24 offset:31744
    ds_read_b64_tr_b16 a[214:215], v24 offset:32000
    v_cndmask_b32 v238, v14, v15, s[4:5]
    v_cndmask_b32 v222, v15, v14, s[4:5]
    v_cmp_le_i32 s[4:5], 27, v10
    s_waitcnt lgkmcnt(4)
    v_mfma_f32_32x32x16_bf16 v[96:111], a[200:203], a[48:51], v[96:111]
    ds_read_b64_tr_b16 a[216:217], v24 offset:32768
    ds_read_b64_tr_b16 a[218:219], v24 offset:33024
    v_mov_b32 v199, 0x3f803f80
    v_cndmask_b32 v239, v14, v15, s[4:5]
    v_cndmask_b32 v223, v15, v14, s[4:5]
    v_mfma_f32_32x32x16_bf16 v[80:95], a[204:207], a[48:51], v[80:95]
    ds_read_b64_tr_b16 a[220:221], v24 offset:33792
    ds_read_b64_tr_b16 a[222:223], v24 offset:34048
    buffer_load_dwordx4 v20, s[16:19], s81 offen offset:2048 lds
    s_waitcnt lgkmcnt(4)
    v_mfma_f32_32x32x16_bf16 v[160:175], a[208:211], a[52:55], v[160:175]
    ds_read_b64_tr_b16 a[200:201], v24 offset:34816
    ds_read_b64_tr_b16 a[202:203], v24 offset:35072
    s_add_u32 m0, s80, 27648
    v_mfma_f32_32x32x16_bf16 v[144:159], a[212:215], a[52:55], v[144:159]
    ds_read_b64_tr_b16 a[204:205], v24 offset:35840
    ds_read_b64_tr_b16 a[206:207], v24 offset:36096
    s_waitcnt lgkmcnt(4)
    v_mfma_f32_32x32x16_bf16 v[128:143], a[216:219], a[52:55], v[128:143]
    ds_read_b64_tr_b16 a[208:209], v24 offset:36864
    ds_read_b64_tr_b16 a[210:211], v24 offset:37120
    buffer_load_dwordx4 v18, s[20:23], s81 offen offset:0 lds
    v_mfma_f32_32x32x16_bf16 v[112:127], a[220:223], a[52:55], v[112:127]
    ds_read_b64_tr_b16 a[212:213], v24 offset:37888
    ds_read_b64_tr_b16 a[214:215], v24 offset:38144
    s_waitcnt lgkmcnt(4)
    v_mfma_f32_32x32x16_bf16 v[96:111], a[200:203], a[52:55], v[96:111]
    ds_read_b64_tr_b16 a[216:217], v24 offset:38912
    ds_read_b64_tr_b16 a[218:219], v24 offset:39168
    v_mfma_f32_32x32x16_bf16 v[80:95], a[204:207], a[52:55], v[80:95]
    ds_read_b64_tr_b16 a[220:221], v24 offset:39936
    ds_read_b64_tr_b16 a[222:223], v24 offset:40192
    buffer_load_dwordx4 v19, s[20:23], s81 offen offset:1024 lds
    s_waitcnt lgkmcnt(4)
    v_mfma_f32_32x32x16_bf16 v[160:175], a[208:211], a[56:59], v[160:175]
    ds_read_b64_tr_b16 a[200:201], v24 offset:40960
    ds_read_b64_tr_b16 a[202:203], v24 offset:41216
    v_mfma_f32_32x32x16_bf16 v[144:159], a[212:215], a[56:59], v[144:159]
    ds_read_b64_tr_b16 a[204:205], v24 offset:41984
    ds_read_b64_tr_b16 a[206:207], v24 offset:42240
    s_waitcnt lgkmcnt(4)
    v_mfma_f32_32x32x16_bf16 v[128:143], a[216:219], a[56:59], v[128:143]
    ds_read_b64_tr_b16 a[208:209], v24 offset:43008
    ds_read_b64_tr_b16 a[210:211], v24 offset:43264
    buffer_load_dwordx4 v20, s[20:23], s81 offen offset:2048 lds
    v_mfma_f32_32x32x16_bf16 v[112:127], a[220:223], a[56:59], v[112:127]
    ds_read_b64_tr_b16 a[212:213], v24 offset:44032
    ds_read_b64_tr_b16 a[214:215], v24 offset:44288
    s_cmp_eq_u32 s62, 11
    s_cselect_b32 s58, 0, 2147483648
    v_or_b32 v2, s58, v37
    v_or_b32 v3, s58, v38
    buffer_load_dword v21, v2, s[24:27], 0 offen
    buffer_load_dword v21, v3, s[28:31], 0 offen
    s_waitcnt lgkmcnt(4)
    v_mfma_f32_32x32x16_bf16 v[96:111], a[200:203], a[56:59], v[96:111]
    ds_read_b64_tr_b16 a[216:217], v24 offset:45056
    ds_read_b64_tr_b16 a[218:219], v24 offset:45312
L_pad_1:
    s_cbranch_execz L_warm_back
    v_mfma_f32_32x32x16_bf16 v[80:95], a[204:207], a[56:59], v[80:95]
    ds_read_b64_tr_b16 a[220:221], v24 offset:46080
    ds_read_b64_tr_b16 a[222:223], v24 offset:46336
    s_waitcnt lgkmcnt(4)
    v_mfma_f32_32x32x16_bf16 v[160:175], a[208:211], a[60:63], v[160:175]
    ds_read_b64_tr_b16 a[200:201], v24 offset:47104
    ds_read_b64_tr_b16 a[202:203], v24 offset:47360
    v_mfma_f32_32x32x16_bf16 v[144:159], a[212:215], a[60:63], v[144:159]
    ds_read_b64_tr_b16 a[204:205], v24 offset:48128
    ds_read_b64_tr_b16 a[206:207], v24 offset:48384
    s_waitcnt lgkmcnt(4)
    v_mfma_f32_32x32x16_bf16 v[128:143], a[216:219], a[60:63], v[128:143]
    s_waitcnt vmcnt(10)
    s_barrier
    ds_read_b64_tr_b16 a[208:209], v22 offset:0
    ds_read_b64_tr_b16 a[210:211], v22 offset:256
    buffer_load_dword v13, v12, s[32:35], 0 offen sc1
    v_mfma_f32_32x32x16_bf16 v[112:127], a[220:223], a[60:63], v[112:127]
    ds_read_b64_tr_b16 a[212:213], v22 offset:1024
    ds_read_b64_tr_b16 a[214:215], v22 offset:1280
    s_add_u32 s79, s73, 6
    s_and_b32 s79, s79, 7
    s_lshl_b32 s80, s83, 1
    s_waitcnt lgkmcnt(4)
    v_mfma_f32_32x32x16_bf16 v[96:111], a[200:203], a[60:63], v[96:111]
    ds_read_b64_tr_b16 a[216:217], v22 offset:2048
    ds_read_b64_tr_b16 a[218:219], v22 offset:2304
    s_add_u32 m0, s80, 49152
    s_mul_i32 s81, s79, 176128
    v_mfma_f32_32x32x16_bf16 v[80:95], a[204:207], a[60:63], v[80:95]
    ds_read_b64_tr_b16 a[220:221], v22 offset:3072
    ds_read_b64_tr_b16 a[222:223], v22 offset:3328
    buffer_load_dwordx4 v18, s[16:19], s81 offen offset:0 lds
    s_waitcnt lgkmcnt(4)
    v_mfma_f32_32x32x16_bf16 v[160:175], a[208:211], a[64:67], v[160:175]
    ds_read_b64_tr_b16 a[200:201], v22 offset:4096
    ds_read_b64_tr_b16 a[202:203], v22 offset:4352
    v_mfma_f32_32x32x16_bf16 v[144:159], a[212:215], a[64:67], v[144:159]
    ds_read_b64_tr_b16 a[204:205], v22 offset:5120
    ds_read_b64_tr_b16 a[206:207], v22 offset:5376
    s_waitcnt lgkmcnt(4)
    v_mfma_f32_32x32x16_bf16 v[128:143], a[216:219], a[64:67], v[128:143]
    ds_read_b64_tr_b16 a[208:209], v22 offset:6144
    ds_read_b64_tr_b16 a[210:211], v22 offset:6400
    buffer_load_dwordx4 v19, s[16:19], s81 offen offset:1024 lds
    v_mfma_f32_32x32x16_bf16 v[112:127], a[220:223], a[64:67], v[112:127]
    ds_read_b64_tr_b16 a[212:213], v22 offset:7168
    ds_read_b64_tr_b16 a[214:215], v22 offset:7424
    s_waitcnt lgkmcnt(4)
    v_mfma_f32_32x32x16_bf16 v[96:111], a[200:203], a[64:67], v[96:111]
    ds_read_b64_tr_b16 a[216:217], v22 offset:8192
    ds_read_b64_tr_b16 a[218:219], v22 offset:8448
    v_mfma_f32_32x32x16_bf16 v[80:95], a[204:207], a[64:67], v[80:95]
    ds_read_b64_tr_b16 a[220:221], v22 offset:9216
    ds_read_b64_tr_b16 a[222:223], v22 offset:9472
    buffer_load_dwordx4 v20, s[16:19], s81 offen offset:2048 lds
    s_waitcnt lgkmcnt(4)
    v_mfma_f32_32x32x16_bf16 v[160:175], a[208:211], a[68:71], v[160:175]
    ds_read_b64_tr_b16 a[200:201], v22 offset:10240
    ds_read_b64_tr_b16 a[202:203], v22 offset:10496
    s_add_u32 m0, s80, 52224
    v_mfma_f32_32x32x16_bf16 v[144:159], a[212:215], a[68:71], v[144:159]
    ds_read_b64_tr_b16 a[204:205], v22 offset:11264
    ds_read_b64_tr_b16 a[206:207], v22 offset:11520
    s_waitcnt lgkmcnt(4)
    v_mfma_f32_32x32x16_bf16 v[128:143], a[216:219], a[68:71], v[128:143]
    ds_read_b64_tr_b16 a[208:209], v22 offset:12288
    ds_read_b64_tr_b16 a[210:211], v22 offset:12544
    buffer_load_dwordx4 v18, s[20:23], s81 offen offset:0 lds
    v_mfma_f32_32x32x16_bf16 v[112:127], a[220:223], a[68:71], v[112:127]
    ds_read_b64_tr_b16 a[212:213], v22 offset:13312
    ds_read_b64_tr_b16 a[214:215], v22 offset:13568
    s_waitcnt lgkmcnt(4)
    v_mfma_f32_32x32x16_bf16 v[96:111], a[200:203], a[68:71], v[96:111]
    ds_read_b64_tr_b16 a[216:217], v22 offset:14336
    ds_read_b64_tr_b16 a[218:219], v22 offset:14592
    v_mfma_f32_32x32x16_bf16 v[80:95], a[204:207], a[68:71], v[80:95]
    ds_read_b64_tr_b16 a[220:221], v22 offset:15360
    ds_read_b64_tr_b16 a[222:223], v22 offset:15616
    buffer_load_dwordx4 v19, s[20:23], s81 offen offset:1024 lds
    s_waitcnt lgkmcnt(4)
    v_mfma_f32_32x32x16_bf16 v[160:175], a[208:211], a[72:75], v[160:175]
    ds_read_b64_tr_b16 a[200:201], v22 offset:16384
    ds_read_b64_tr_b16 a[202:203], v22 offset:16640
    v_mfma_f32_32x32x16_bf16 v[144:159], a[212:215], a[72:75], v[144:159]
    ds_read_b64_tr_b16 a[204:205], v22 offset:17408
    ds_read_b64_tr_b16 a[206:207], v22 offset:17664
    s_waitcnt lgkmcnt(4)
    v_mfma_f32_32x32x16_bf16 v[128:143], a[216:219], a[72:75], v[128:143]
    ds_read_b64_tr_b16 a[208:209], v22 offset:18432
    ds_read_b64_tr_b16 a[210:211], v22 offset:18688
    buffer_load_dwordx4 v20, s[20:23], s81 offen offset:2048 lds
    v_mfma_f32_32x32x16_bf16 v[112:127], a[220:223], a[72:75], v[112:127]
    ds_read_b64_tr_b16 a[212:213], v22 offset:19456
    ds_read_b64_tr_b16 a[214:215], v22 offset:19712
    s_cmp_eq_u32 s62, 12
    s_cselect_b32 s58, 0, 2147483648
    v_or_b32 v2, s58, v37
    v_or_b32 v3, s58, v38
    buffer_load_dword v21, v2, s[24:27], 0 offen
    buffer_load_dword v21, v3, s[28:31], 0 offen
    s_waitcnt lgkmcnt(4)
    v_mfma_f32_32x32x16_bf16 v[96:111], a[200:203], a[72:75], v[96:111]
    ds_read_b64_tr_b16 a[216:217], v22 offset:20480
    ds_read_b64_tr_b16 a[218:219], v22 offset:20736
    v_mfma_f32_32x32x16_bf16 v[80:95], a[204:207], a[72:75], v[80:95]
    ds_read_b64_tr_b16 a[220:221], v22 offset:21504
    ds_read_b64_tr_b16 a[222:223], v22 offset:21760
    s_waitcnt lgkmcnt(4)
    v_mfma_f32_32x32x16_bf16 v[160:175], a[208:211], a[76:79], v[160:175]
    ds_read_b64_tr_b16 a[200:201], v22 offset:22528
    ds_read_b64_tr_b16 a[202:203], v22 offset:22784
    v_mfma_f32_32x32x16_bf16 v[144:159], a[212:215], a[76:79], v[144:159]
    ds_read_b64_tr_b16 a[204:205], v22 offset:23552
    ds_read_b64_tr_b16 a[206:207], v22 offset:23808
    s_waitcnt lgkmcnt(4)
    v_mfma_f32_32x32x16_bf16 v[128:143], a[216:219], a[76:79], v[128:143]
    s_waitcnt vmcnt(11)
    s_barrier
    ds_read_b64_tr_b16 a[208:209], v22 offset:24576
    ds_read_b64_tr_b16 a[210:211], v22 offset:24832
    s_add_u32 s79, s73, 7
    v_mfma_f32_32x32x16_bf16 v[112:127], a[220:223], a[76:79], v[112:127]
    ds_read_b64_tr_b16 a[212:213], v22 offset:25600
    ds_read_b64_tr_b16 a[214:215], v22 offset:25856
    s_and_b32 s79, s79, 7
    s_lshl_b32 s80, s83, 1
    s_add_u32 m0, s80, 73728
    s_waitcnt lgkmcnt(4)
    v_mfma_f32_32x32x16_bf16 v[96:111], a[200:203], a[76:79], v[96:111]
    ds_read_b64_tr_b16 a[216:217], v22 offset:26624
    ds_read_b64_tr_b16 a[218:219], v22 offset:26880
    s_mul_i32 s81, s79, 176128
    v_mfma_f32_32x32x16_bf16 v[80:95], a[204:207], a[76:79], v[80:95]
    ds_read_b64_tr_b16 a[220:221], v22 offset:27648
    ds_read_b64_tr_b16 a[222:223], v22 offset:27904
    buffer_load_dwordx4 v18, s[16:19], s81 offen offset:0 lds
    s_waitcnt lgkmcnt(4)
    v_mfma_f32_32x32x16_bf16 v[160:175], a[208:211], a[80:83], v[160:175]
    ds_read_b64_tr_b16 a[200:201], v22 offset:28672
    ds_read_b64_tr_b16 a[202:203], v22 offset:28928
    v_mfma_f32_32x32x16_bf16 v[144:159], a[212:215], a[80:83], v[144:159]
    ds_read_b64_tr_b16 a[204:205], v22 offset:29696
    ds_read_b64_tr_b16 a[206:207], v22 offset:29952
    s_waitcnt lgkmcnt(4)
    v_mfma_f32_32x32x16_bf16 v[128:143], a[216:219], a[80:83], v[128:143]
    ds_read_b64_tr_b16 a[208:209], v22 offset:30720
    ds_read_b64_tr_b16 a[210:211], v22 offset:30976
    buffer_load_dwordx4 v19, s[16:19], s81 offen offset:1024 lds
    v_mfma_f32_32x32x16_bf16 v[112:127], a[220:223], a[80:83], v[112:127]
    ds_read_b64_tr_b16 a[212:213], v22 offset:31744
    ds_read_b64_tr_b16 a[214:215], v22 offset:32000
    s_waitcnt lgkmcnt(4)
    v_mfma_f32_32x32x16_bf16 v[96:111], a[200:203], a[80:83], v[96:111]
    ds_read_b64_tr_b16 a[216:217], v22 offset:32768
    ds_read_b64_tr_b16 a[218:219], v22 offset:33024
    v_mfma_f32_32x32x16_bf16 v[80:95], a[204:207], a[80:83], v[80:95]
    ds_read_b64_tr_b16 a[220:221], v22 offset:33792
    ds_read_b64_tr_b16 a[222:223], v22 offset:34048
    buffer_load_dwordx4 v20, s[16:19], s81 offen offset:2048 lds
    s_waitcnt lgkmcnt(4)
    v_mfma_f32_32x32x16_bf16 v[160:175], a[208:211], a[84:87], v[160:175]
    ds_read_b64_tr_b16 a[200:201], v22 offset:34816
    ds_read_b64_tr_b16 a[202:203], v22 offset:35072
    s_add_u32 m0, s80, 76800
    v_mfma_f32_32x32x16_bf16 v[144:159], a[212:215], a[84:87], v[144:159]
    ds_read_b64_tr_b16 a[204:205], v22 offset:35840
    ds_read_b64_tr_b16 a[206:207], v22 offset:36096
    s_waitcnt lgkmcnt(4)
    v_mfma_f32_32x32x16_bf16 v[128:143], a[216:219], a[84:87], v[128:143]
    ds_read_b64_tr_b16 a[208:209], v22 offset:36864
    ds_read_b64_tr_b16 a[210:211], v22 offset:37120
    buffer_load_dwordx4 v18, s[20:23], s81 offen offset:0 lds
    v_mfma_f32_32x32x16_bf16 v[112:127], a[220:223], a[84:87], v[112:127]
    ds_read_b64_tr_b16 a[212:213], v22 offset:37888
    ds_read_b64_tr_b16 a[214:215], v22 offset:38144
    s_waitcnt lgkmcnt(4)
    v_mfma_f32_32x32x16_bf16 v[96:111], a[200:203], a[84:87], v[96:111]
    ds_read_b64_tr_b16 a[216:217], v22 offset:38912
    ds_read_b64_tr_b16 a[218:219], v22 offset:39168
    v_mfma_f32_32x32x16_bf16 v[80:95], a[204:207], a[84:87], v[80:95]
    ds_read_b64_tr_b16 a[220:221], v22 offset:39936
    ds_read_b64_tr_b16 a[222:223], v22 offset:40192
    buffer_load_dwordx4 v19, s[20:23], s81 offen offset:1024 lds
    s_waitcnt lgkmcnt(4)
    v_mfma_f32_32x32x16_bf16 v[160:175], a[208:211], a[88:91], v[160:175]
    ds_read_b64_tr_b16 a[200:201], v22 offset:40960
    ds_read_b64_tr_b16 a[202:203], v22 offset:41216
    v_mfma_f32_32x32x16_bf16 v[144:159], a[212:215], a[88:91], v[144:159]
    ds_read_b64_tr_b16 a[204:205], v22 offset:41984
    ds_read_b64_tr_b16 a[206:207], v22 offset:42240
    s_waitcnt lgkmcnt(4)
    v_mfma_f32_32x32x16_bf16 v[128:143], a[216:219], a[88:91], v[128:143]
    ds_read_b64_tr_b16 a[208:209], v22 offset:43008
    ds_read_b64_tr_b16 a[210:211], v22 offset:43264
    buffer_load_dwordx4 v20, s[20:23], s81 offen offset:2048 lds
    v_mfma_f32_32x32x16_bf16 v[112:127], a[220:223], a[88:91], v[112:127]
    ds_read_b64_tr_b16 a[212:213], v22 offset:44032
    ds_read_b64_tr_b16 a[214:215], v22 offset:44288
    s_waitcnt vmcnt(14)
    v_cmp_ne_u32 vcc, s50, v13
    s_mov_b32 s93, 0
    s_cbranch_vccz L_kv_ok
L_kv_retry:
    buffer_load_dword v13, v12, s[32:35], 0 offen sc1
    s_add_u32 s93, s93, 1
    s_cmp_ge_u32 s93, 0x40000
    s_waitcnt vmcnt(0)
    v_cmp_ne_u32 vcc, s50, v13
    s_cbranch_scc1 L_kv_ok
    s_cbranch_vccnz L_kv_retry
L_kv_ok:
    s_waitcnt lgkmcnt(4)
    v_mfma_f32_32x32x16_bf16 v[96:111], a[200:203], a[88:91], v[96:111]
    ds_read_b64_tr_b16 a[216:217], v22 offset:45056
    ds_read_b64_tr_b16 a[218:219], v22 offset:45312
    v_add_u32 v1, s53, v11
    s_lshl_b32 s78, s70, 13
    v_mfma_f32_32x32x16_bf16 v[80:95], a[204:207], a[88:91], v[80:95]
    ds_read_b64_tr_b16 a[220:221], v22 offset:46080
    ds_read_b64_tr_b16 a[222:223], v22 offset:46336
    s_add_u32 m0, s78, 114688
    s_mov_b32 s77, 0
    buffer_load_dwordx4 v1, s[32:35], s77 offen offset:0 sc1 lds
    s_waitcnt lgkmcnt(4)
    v_mfma_f32_32x32x16_bf16 v[160:175], a[208:211], a[92:95], v[160:175]
    ds_read_b64_tr_b16 a[200:201], v22 offset:47104
    ds_read_b64_tr_b16 a[202:203], v22 offset:47360
    v_mfma_f32_32x32x16_bf16 v[144:159], a[212:215], a[92:95], v[144:159]
    ds_read_b64_tr_b16 a[204:205], v22 offset:48128
    ds_read_b64_tr_b16 a[206:207], v22 offset:48384
    s_waitcnt lgkmcnt(4)
    v_mfma_f32_32x32x16_bf16 v[128:143], a[216:219], a[92:95], v[128:143]
    s_waitcnt vmcnt(9)
    s_barrier
    ds_read_b64_tr_b16 a[208:209], v24 offset:0
    ds_read_b64_tr_b16 a[210:211], v24 offset:256
    buffer_load_dwordx4 v1, s[32:35], s77 offen offset:1024 sc1 lds
    v_mfma_f32_32x32x16_bf16 v[112:127], a[220:223], a[92:95], v[112:127]
    ds_read_b64_tr_b16 a[212:213], v24 offset:3072
    ds_read_b64_tr_b16 a[214:215], v24 offset:3328
    s_waitcnt lgkmcnt(4)
    v_mfma_f32_32x32x16_bf16 v[96:111], a[200:203], a[92:95], v[96:111]
    ds_read_b64_tr_b16 a[216:217], v24 offset:6144
    ds_read_b64_tr_b16 a[218:219], v24 offset:6400
    v_mfma_f32_32x32x16_bf16 v[80:95], a[204:207], a[92:95], v[80:95]
    ds_read_b64_tr_b16 a[220:221], v24 offset:9216
    ds_read_b64_tr_b16 a[222:223], v24 offset:9472
    s_waitcnt lgkmcnt(4)
    v_mfma_f32_32x32x16_bf16 v[160:175], a[208:211], a[96:99], v[160:175]
    ds_read_b64_tr_b16 a[200:201], v24 offset:12288
    ds_read_b64_tr_b16 a[202:203], v24 offset:12544
    buffer_load_dwordx4 v1, s[32:35], s77 offen offset:2048 sc1 lds
    v_mfma_f32_32x32x16_bf16 v[112:127], a[212:215], a[96:99], v[112:127]
    ds_read_b64_tr_b16 a[204:205], v24 offset:15360
    ds_read_b64_tr_b16 a[206:207], v24 offset:15616
    s_waitcnt lgkmcnt(4)
    v_mfma_f32_32x32x16_bf16 v[160:175], a[216:219], a[100:103], v[160:175]
    ds_read_b64_tr_b16 a[208:209], v24 offset:18432
    ds_read_b64_tr_b16 a[210:211], v24 offset:18688
    v_mfma_f32_32x32x16_bf16 v[112:127], a[220:223], a[100:103], v[112:127]
    ds_read_b64_tr_b16 a[212:213], v24 offset:21504
    ds_read_b64_tr_b16 a[214:215], v24 offset:21760
    s_waitcnt lgkmcnt(4)
    v_mfma_f32_32x32x16_bf16 v[160:175], a[200:203], a[104:107], v[160:175]
    s_waitcnt vmcnt(3)
    s_barrier
    ds_read_b64_tr_b16 a[216:217], v24 offset:24576
    ds_read_b64_tr_b16 a[218:219], v24 offset:24832
    buffer_load_dwordx4 v1, s[32:35], s77 offen offset:3072 sc1 lds
    v_mfma_f32_32x32x16_bf16 v[112:127], a[204:207], a[104:107], v[112:127]
    ds_read_b64_tr_b16 a[220:221], v24 offset:27648
    ds_read_b64_tr_b16 a[222:223], v24 offset:27904
    s_waitcnt lgkmcnt(4)
    v_mfma_f32_32x32x16_bf16 v[160:175], a[208:211], a[108:111], v[160:175]
    ds_read_b64_tr_b16 a[200:201], v24 offset:30720
    ds_read_b64_tr_b16 a[202:203], v24 offset:30976
    v_mfma_f32_32x32x16_bf16 v[112:127], a[212:215], a[108:111], v[112:127]
    ds_read_b64_tr_b16 a[204:205], v24 offset:33792
    ds_read_b64_tr_b16 a[206:207], v24 offset:34048
    s_waitcnt lgkmcnt(4)
    v_mfma_f32_32x32x16_bf16 v[160:175], a[216:219], a[112:115], v[160:175]
    ds_read_b64_tr_b16 a[208:209], v24 offset:36864
    ds_read_b64_tr_b16 a[210:211], v24 offset:37120
    s_add_u32 m0, s78, 118784
    s_mov_b32 s77, 4096
    buffer_load_dwordx4 v1, s[32:35], s77 offen offset:0 sc1 lds
    v_mfma_f32_32x32x16_bf16 v[112:127], a[220:223], a[112:115], v[112:127]
    ds_read_b64_tr_b16 a[212:213], v24 offset:39936
    ds_read_b64_tr_b16 a[214:215], v24 offset:40192
    s_waitcnt lgkmcnt(4)
    v_mfma_f32_32x32x16_bf16 v[160:175], a[200:203], a[116:119], v[160:175]
    ds_read_b64_tr_b16 a[216:217], v24 offset:43008
    ds_read_b64_tr_b16 a[218:219], v24 offset:43264
    v_mfma_f32_32x32x16_bf16 v[112:127], a[204:207], a[116:119], v[112:127]
    ds_read_b64_tr_b16 a[220:221], v24 offset:46080
    ds_read_b64_tr_b16 a[222:223], v24 offset:46336
    buffer_load_dwordx4 v1, s[32:35], s77 offen offset:1024 sc1 lds
    s_waitcnt lgkmcnt(4)
    v_mfma_f32_32x32x16_bf16 v[160:175], a[208:211], a[120:123], v[160:175]
    ds_read_b64_tr_b16 a[200:201], v24 offset:1024
    ds_read_b64_tr_b16 a[202:203], v24 offset:1280
    v_mfma_f32_32x32x16_bf16 v[112:127], a[212:215], a[120:123], v[112:127]
    ds_read_b64_tr_b16 a[204:205], v24 offset:4096
    ds_read_b64_tr_b16 a[206:207], v24 offset:4352
    s_waitcnt lgkmcnt(4)
    v_mfma_f32_32x32x16_bf16 v[160:175], a[216:219], a[124:127], v[160:175]
    ds_read_b64_tr_b16 a[208:209], v24 offset:7168
    ds_read_b64_tr_b16 a[210:211], v24 offset:7424
    v_mfma_f32_32x32x16_bf16 v[112:127], a[220:223], a[124:127], v[112:127]
    ds_read_b64_tr_b16 a[212:213], v24 offset:10240
    ds_read_b64_tr_b16 a[214:215], v24 offset:10496
    buffer_load_dwordx4 v1, s[32:35], s77 offen offset:2048 sc1 lds
    s_waitcnt lgkmcnt(4)
    v_mfma_f32_32x32x16_bf16 v[144:159], a[200:203], a[96:99], v[144:159]
    ds_read_b64_tr_b16 a[216:217], v24 offset:13312
    ds_read_b64_tr_b16 a[218:219], v24 offset:13568
    v_mfma_f32_32x32x16_bf16 v[96:111], a[204:207], a[96:99], v[96:111]
    ds_read_b64_tr_b16 a[220:221], v24 offset:16384
    ds_read_b64_tr_b16 a[222:223], v24 offset:16640
    v_mul_f32 v160, s90, v160
    v_mul_f32 v161, s90, v161
    v_mul_f32 v162, s90, v162
    v_mul_f32 v163, s90, v163
    v_mul_f32 v164, s90, v164
    v_mul_f32 v165, s90, v165
    s_waitcnt lgkmcnt(4)
    v_mfma_f32_32x32x16_bf16 v[144:159], a[208:211], a[100:103], v[144:159]
    ds_read_b64_tr_b16 a[200:201], v24 offset:19456
    ds_read_b64_tr_b16 a[202:203], v24 offset:19712
    buffer_load_dwordx4 v1, s[32:35], s77 offen offset:3072 sc1 lds
    v_mul_f32 v166, s90, v166
    v_mul_f32 v167, s90, v167
    v_exp_f32 v160, v160
    v_exp_f32 v161, v161
    v_exp_f32 v162, v162
    v_exp_f32 v163, v163
    v_mfma_f32_32x32x16_bf16 v[96:111], a[212:215], a[100:103], v[96:111]
    ds_read_b64_tr_b16 a[204:205], v24 offset:22528
    ds_read_b64_tr_b16 a[206:207], v24 offset:22784
    v_exp_f32 v164, v164
    v_exp_f32 v165, v165
    v_exp_f32 v166, v166
    v_exp_f32 v167, v167
    v_fma_f32 v160, v160, v8, v8
    v_fma_f32 v161, v161, v8, v8
    s_waitcnt lgkmcnt(4)
    v_mfma_f32_32x32x16_bf16 v[144:159], a[216:219], a[104:107], v[144:159]
    ds_read_b64_tr_b16 a[208:209], v24 offset:25600
    ds_read_b64_tr_b16 a[210:211], v24 offset:25856
    s_add_u32 m0, s82, 98304
    s_add_u32 s79, s6, 0
    buffer_load_dwordx4 v26, s[24:27], s79 offen offset:0 lds
    v_fma_f32 v162, v162, v8, v8
    v_fma_f32 v163, v163, v8, v8
    v_fma_f32 v164, v164, v8, v8
    v_fma_f32 v165, v165, v8, v8
    v_fma_f32 v166, v166, v8, v8
    v_fma_f32 v167, v167, v8, v8
    v_mfma_f32_32x32x16_bf16 v[96:111], a[220:223], a[104:107], v[96:111]
    ds_read_b64_tr_b16 a[212:213], v24 offset:28672
    ds_read_b64_tr_b16 a[214:215], v24 offset:28928
    v_rcp_f32 v160, v160
    v_rcp_f32 v161, v161
    v_rcp_f32 v162, v162
    v_rcp_f32 v163, v163
    v_rcp_f32 v164, v164
    v_rcp_f32 v165, v165
    s_waitcnt lgkmcnt(4)
    v_mfma_f32_32x32x16_bf16 v[144:159], a[200:203], a[108:111], v[144:159]
    ds_read_b64_tr_b16 a[216:217], v24 offset:31744
    ds_read_b64_tr_b16 a[218:219], v24 offset:32000
    buffer_load_dwordx4 v27, s[24:27], s79 offen offset:1024 lds
    v_rcp_f32 v166, v166
    v_rcp_f32 v167, v167
    v_mul_f32 v160, v160, v112
    v_mul_f32 v161, v161, v113
    v_mul_f32 v162, v162, v114
    v_mul_f32 v163, v163, v115
    v_mfma_f32_32x32x16_bf16 v[96:111], a[204:207], a[108:111], v[96:111]
    ds_read_b64_tr_b16 a[220:221], v24 offset:34816
    ds_read_b64_tr_b16 a[222:223], v24 offset:35072
    v_mul_f32 v164, v164, v116
    v_mul_f32 v165, v165, v117
    v_mul_f32 v166, v166, v118
    v_mul_f32 v167, v167, v119
    v_cvt_pk_bf16_f32 v240, v160, v161
    v_cvt_pk_bf16_f32 v241, v162, v163
    s_waitcnt lgkmcnt(4)
    v_mfma_f32_32x32x16_bf16 v[144:159], a[208:211], a[112:115], v[144:159]
    ds_read_b64_tr_b16 a[200:201], v24 offset:37888
    ds_read_b64_tr_b16 a[202:203], v24 offset:38144
    buffer_load_dwordx4 v28, s[24:27], s79 offen offset:2048 lds
    v_cvt_pk_bf16_f32 v242, v164, v165
    v_cvt_pk_bf16_f32 v243, v166, v167
    buffer_store_dwordx4 v[240:243], v34, s[32:35], 0 offen offset:0 sc1
    v_mul_f32 v168, s90, v168
    v_mul_f32 v169, s90, v169
    v_mul_f32 v170, s90, v170
    v_mfma_f32_32x32x16_bf16 v[96:111], a[212:215], a[112:115], v[96:111]
    ds_read_b64_tr_b16 a[204:205], v24 offset:40960
    ds_read_b64_tr_b16 a[206:207], v24 offset:41216
    v_mul_f32 v171, s90, v171
    v_mul_f32 v172, s90, v172
    v_mul_f32 v173, s90, v173
    v_mul_f32 v174, s90, v174
    v_mul_f32 v175, s90, v175
    v_exp_f32 v168, v168
    s_waitcnt lgkmcnt(4)
    v_mfma_f32_32x32x16_bf16 v[144:159], a[216:219], a[116:119], v[144:159]
    ds_read_b64_tr_b16 a[208:209], v24 offset:44032
    ds_read_b64_tr_b16 a[210:211], v24 offset:44288
    buffer_load_dwordx4 v29, s[24:27], s79 offen offset:3072 lds
    v_exp_f32 v169, v169
    v_exp_f32 v170, v170
    v_exp_f32 v171, v171
    v_exp_f32 v172, v172
    v_exp_f32 v173, v173
    v_exp_f32 v174, v174
    v_mfma_f32_32x32x16_bf16 v[96:111], a[220:223], a[116:119], v[96:111]
    ds_read_b64_tr_b16 a[212:213], v24 offset:47104
    ds_read_b64_tr_b16 a[214:215], v24 offset:47360
    s_add_u32 m0, s82, 0
    s_add_u32 s79, s7, 0
    buffer_load_dwordx4 v26, s[28:31], s79 offen offset:0 lds
    v_exp_f32 v175, v175
    v_fma_f32 v168, v168, v8, v8
    v_fma_f32 v169, v169, v8, v8
    v_fma_f32 v170, v170, v8, v8
    v_fma_f32 v171, v171, v8, v8
    s_waitcnt lgkmcnt(4)
    v_mfma_f32_32x32x16_bf16 v[144:159], a[200:203], a[120:123], v[144:159]
    ds_read_b64_tr_b16 a[216:217], v24 offset:2048
    ds_read_b64_tr_b16 a[218:219], v24 offset:2304
    v_fma_f32 v172, v172, v8, v8
    v_fma_f32 v173, v173, v8, v8
    v_fma_f32 v174, v174, v8, v8
    v_fma_f32 v175, v175, v8, v8
    v_rcp_f32 v168, v168
    v_mfma_f32_32x32x16_bf16 v[96:111], a[204:207], a[120:123], v[96:111]
    ds_read_b64_tr_b16 a[220:221], v24 offset:5120
    ds_read_b64_tr_b16 a[222:223], v24 offset:5376
    buffer_load_dwordx4 v27, s[28:31], s79 offen offset:1024 lds
    v_rcp_f32 v169, v169
    v_rcp_f32 v170, v170
    v_rcp_f32 v171, v171
    v_rcp_f32 v172, v172
    v_rcp_f32 v173, v173
    s_waitcnt lgkmcnt(4)
    v_mfma_f32_32x32x16_bf16 v[144:159], a[208:211], a[124:127], v[144:159]
    ds_read_b64_tr_b16 a[200:201], v24 offset:8192
    ds_read_b64_tr_b16 a[202:203], v24 offset:8448
    buffer_load_dwordx4 v28, s[28:31], s79 offen offset:2048 lds
    v_rcp_f32 v174, v174
    v_rcp_f32 v175, v175
    v_mul_f32 v168, v168, v120
    v_mul_f32 v169, v169, v121
    v_mul_f32 v170, v170, v122
    v_mfma_f32_32x32x16_bf16 v[96:111], a[212:215], a[124:127], v[96:111]
    ds_read_b64_tr_b16 a[204:205], v24 offset:11264
    ds_read_b64_tr_b16 a[206:207], v24 offset:11520
    v_mul_f32 v171, v171, v123
    v_mul_f32 v172, v172, v124
    v_mul_f32 v173, v173, v125
    v_mul_f32 v174, v174, v126
    v_mul_f32 v175, v175, v127
    s_waitcnt lgkmcnt(4)
    v_mfma_f32_32x32x16_bf16 v[128:143], a[216:219], a[96:99], v[128:143]
    ds_read_b64_tr_b16 a[208:209], v24 offset:14336
    ds_read_b64_tr_b16 a[210:211], v24 offset:14592
    buffer_load_dwordx4 v29, s[28:31], s79 offen offset:3072 lds
    v_cvt_pk_bf16_f32 v244, v168, v169
    v_mfma_f32_32x32x16_bf16 v[80:95], a[220:223], a[96:99], v[80:95]
    ds_read_b64_tr_b16 a[212:213], v24 offset:17408
    ds_read_b64_tr_b16 a[214:215], v24 offset:17664
    v_cvt_pk_bf16_f32 v245, v170, v171
    v_cvt_pk_bf16_f32 v246, v172, v173
    v_cvt_pk_bf16_f32 v247, v174, v175
    buffer_store_dwordx4 v[244:247], v34, s[32:35], 0 offen offset:1024 sc1
    v_mul_f32 v144, s90, v144
    v_mul_f32 v145, s90, v145
    s_waitcnt lgkmcnt(4)
    v_mfma_f32_32x32x16_bf16 v[128:143], a[200:203], a[100:103], v[128:143]
    ds_read_b64_tr_b16 a[216:217], v24 offset:20480
    ds_read_b64_tr_b16 a[218:219], v24 offset:20736
    s_add_u32 m0, s82, 16384
    s_add_u32 s79, s7, 32768
    buffer_load_dwordx4 v26, s[28:31], s79 offen offset:0 lds
    v_mul_f32 v146, s90, v146
    v_mul_f32 v147, s90, v147
    v_mul_f32 v148, s90, v148
    v_mul_f32 v149, s90, v149
    v_mul_f32 v150, s90, v150
    v_mul_f32 v151, s90, v151
    v_mfma_f32_32x32x16_bf16 v[80:95], a[204:207], a[100:103], v[80:95]
    ds_read_b64_tr_b16 a[220:221], v24 offset:23552
    ds_read_b64_tr_b16 a[222:223], v24 offset:23808
    v_exp_f32 v144, v144
    v_exp_f32 v145, v145
    v_exp_f32 v146, v146
    v_exp_f32 v147, v147
    v_exp_f32 v148, v148
    v_exp_f32 v149, v149
    s_waitcnt lgkmcnt(4)
    v_mfma_f32_32x32x16_bf16 v[128:143], a[208:211], a[104:107], v[128:143]
    ds_read_b64_tr_b16 a[200:201], v24 offset:26624
    ds_read_b64_tr_b16 a[202:203], v24 offset:26880
    buffer_load_dwordx4 v27, s[28:31], s79 offen offset:1024 lds
    v_exp_f32 v150, v150
    v_exp_f32 v151, v151
    v_fma_f32 v144, v144, v8, v8
    v_fma_f32 v145, v145, v8, v8
    v_fma_f32 v146, v146, v8, v8
    v_fma_f32 v147, v147, v8, v8
    v_mfma_f32_32x32x16_bf16 v[80:95], a[212:215], a[104:107], v[80:95]
    ds_read_b64_tr_b16 a[204:205], v24 offset:29696
    ds_read_b64_tr_b16 a[206:207], v24 offset:29952
    s_waitcnt vmcnt(7)
    ds_read_b64_tr_b16 a[128:129], v30 offset:49152
    ds_read_b64_tr_b16 a[130:131], v30 offset:49664
    v_fma_f32 v148, v148, v8, v8
    v_fma_f32 v149, v149, v8, v8
    v_fma_f32 v150, v150, v8, v8
    v_fma_f32 v151, v151, v8, v8
    v_rcp_f32 v144, v144
    v_rcp_f32 v145, v145
    s_waitcnt lgkmcnt(6)
    v_mfma_f32_32x32x16_bf16 v[128:143], a[216:219], a[108:111], v[128:143]
    ds_read_b64_tr_b16 a[208:209], v24 offset:32768
    ds_read_b64_tr_b16 a[210:211], v24 offset:33024
    buffer_load_dwordx4 v28, s[28:31], s79 offen offset:2048 lds
    v_rcp_f32 v146, v146
    v_rcp_f32 v147, v147
    v_rcp_f32 v148, v148
    v_rcp_f32 v149, v149
    v_rcp_f32 v150, v150
    v_rcp_f32 v151, v151
    v_mfma_f32_32x32x16_bf16 v[80:95], a[220:223], a[108:111], v[80:95]
    ds_read_b64_tr_b16 a[212:213], v24 offset:35840
    ds_read_b64_tr_b16 a[214:215], v24 offset:36096
    buffer_load_dwordx4 v29, s[28:31], s79 offen offset:3072 lds
    v_mul_f32 v144, v144, v96
    v_mul_f32 v145, v145, v97
    v_mul_f32 v146, v146, v98
    v_mul_f32 v147, v147, v99
    v_mul_f32 v148, v148, v100
    v_mul_f32 v149, v149, v101
    s_waitcnt lgkmcnt(6)
    v_mfma_f32_32x32x16_bf16 v[128:143], a[200:203], a[112:115], v[128:143]
    ds_read_b64_tr_b16 a[216:217], v24 offset:38912
    ds_read_b64_tr_b16 a[218:219], v24 offset:39168
    ds_read_b64_tr_b16 a[132:133], v31 offset:49152
    ds_read_b64_tr_b16 a[134:135], v31 offset:49664
    v_mul_f32 v150, v150, v102
    v_mul_f32 v151, v151, v103
    v_cvt_pk_bf16_f32 v240, v144, v145
    v_cvt_pk_bf16_f32 v241, v146, v147
    v_cvt_pk_bf16_f32 v242, v148, v149
    v_cvt_pk_bf16_f32 v243, v150, v151
    v_mfma_f32_32x32x16_bf16 v[80:95], a[204:207], a[112:115], v[80:95]
    ds_read_b64_tr_b16 a[220:221], v24 offset:41984
    ds_read_b64_tr_b16 a[222:223], v24 offset:42240
    s_add_u32 m0, s82, 32768
    s_add_u32 s79, s7, 65536
    buffer_load_dwordx4 v26, s[28:31], s79 offen offset:0 lds
    buffer_store_dwordx4 v[240:243], v34, s[32:35], 0 offen offset:2048 sc1
    v_mul_f32 v152, s90, v152
    v_mul_f32 v153, s90, v153
    v_mul_f32 v154, s90, v154
    v_mul_f32 v155, s90, v155
    v_mul_f32 v156, s90, v156
    s_waitcnt lgkmcnt(6)
    v_mfma_f32_32x32x16_bf16 v[128:143], a[208:211], a[116:119], v[128:143]
    ds_read_b64_tr_b16 a[200:201], v24 offset:45056
    ds_read_b64_tr_b16 a[202:203], v24 offset:45312
    buffer_load_dwordx4 v27, s[28:31], s79 offen offset:1024 lds
    v_mul_f32 v157, s90, v157
    v_mul_f32 v158, s90, v158
    v_mul_f32 v159, s90, v159
    v_exp_f32 v152, v152
    v_exp_f32 v153, v153
    v_exp_f32 v154, v154
    v_mfma_f32_32x32x16_bf16 v[80:95], a[212:215], a[116:119], v[80:95]
    ds_read_b64_tr_b16 a[204:205], v24 offset:48128
    ds_read_b64_tr_b16 a[206:207], v24 offset:48384
    ds_read_b64_tr_b16 a[136:137], v32 offset:49152
    ds_read_b64_tr_b16 a[138:139], v32 offset:49664
    v_exp_f32 v155, v155
    v_exp_f32 v156, v156
    v_exp_f32 v157, v157
    v_exp_f32 v158, v158
    v_exp_f32 v159, v159
    v_fma_f32 v152, v152, v8, v8
    s_waitcnt lgkmcnt(6)
    v_mfma_f32_32x32x16_bf16 v[128:143], a[216:219], a[120:123], v[128:143]
    buffer_load_dwordx4 v28, s[28:31], s79 offen offset:2048 lds
    v_fma_f32 v153, v153, v8, v8
    v_fma_f32 v154, v154, v8, v8
    v_fma_f32 v155, v155, v8, v8
    v_fma_f32 v156, v156, v8, v8
    v_fma_f32 v157, v157, v8, v8
    v_fma_f32 v158, v158, v8, v8
    v_mfma_f32_32x32x16_bf16 v[80:95], a[220:223], a[120:123], v[80:95]
    ds_read_b64_tr_b16 a[140:141], v33 offset:49152
    ds_read_b64_tr_b16 a[142:143], v33 offset:49664
    v_fma_f32 v159, v159, v8, v8
    v_rcp_f32 v152, v152
    v_rcp_f32 v153, v153
    v_rcp_f32 v154, v154
    v_rcp_f32 v155, v155
    v_rcp_f32 v156, v156
    s_waitcnt lgkmcnt(4)
    v_mfma_f32_32x32x16_bf16 v[128:143], a[200:203], a[124:127], v[128:143]
    buffer_load_dwordx4 v29, s[28:31], s79 offen offset:3072 lds
L_pad_2:
    s_cbranch_execz L_warm_back
    v_rcp_f32 v157, v157
    v_rcp_f32 v158, v158
    v_rcp_f32 v159, v159
    v_mul_f32 v152, v152, v104
    v_mul_f32 v153, v153, v105
    v_mul_f32 v154, v154, v106
    v_mfma_f32_32x32x16_bf16 v[80:95], a[204:207], a[124:127], v[80:95]
    s_waitcnt lgkmcnt(0)
    v_mul_f32 v155, v155, v107
    v_mul_f32 v156, v156, v108
    v_mul_f32 v157, v157, v109
    v_mul_f32 v158, v158, v110
    v_mul_f32 v159, v159, v111
    v_cvt_pk_bf16_f32 v244, v152, v153
    v_cvt_pk_bf16_f32 v245, v154, v155
    v_cvt_pk_bf16_f32 v246, v156, v157
    v_cvt_pk_bf16_f32 v247, v158, v159
    buffer_store_dwordx4 v[244:247], v34, s[32:35], 0 offen offset:3072 sc1
    s_barrier
    v_pk_mul_f32 v[128:129], v[128:129], s[90:91]
    v_pk_mul_f32 v[130:131], v[130:131], s[90:91]
    v_pk_mul_f32 v[132:133], v[132:133], s[90:91]
    v_pk_mul_f32 v[134:135], v[134:135], s[90:91]
    v_exp_f32 v128, v128
    v_exp_f32 v129, v129
    v_exp_f32 v130, v130
    v_exp_f32 v131, v131
    v_exp_f32 v132, v132
    v_exp_f32 v133, v133
    v_exp_f32 v134, v134
    v_exp_f32 v135, v135
    v_pk_fma_f32 v[128:129], v[128:129], v[8:9], v[8:9]
    v_pk_fma_f32 v[130:131], v[130:131], v[8:9], v[8:9]
    v_pk_fma_f32 v[132:133], v[132:133], v[8:9], v[8:9]
    v_pk_fma_f32 v[134:135], v[134:135], v[8:9], v[8:9]
    v_rcp_f32 v128, v128
    v_rcp_f32 v129, v129
    v_rcp_f32 v130, v130
    v_rcp_f32 v131, v131
    v_rcp_f32 v132, v132
    v_rcp_f32 v133, v133
    v_rcp_f32 v134, v134
    v_rcp_f32 v135, v135
    v_pk_mul_f32 v[128:129], v[128:129], v[80:81]
    v_pk_mul_f32 v[130:131], v[130:131], v[82:83]
    v_pk_mul_f32 v[132:133], v[132:133], v[84:85]
    v_pk_mul_f32 v[134:135], v[134:135], v[86:87]
    v_cvt_pk_bf16_f32 v240, v128, v129
    v_cvt_pk_bf16_f32 v241, v130, v131
    v_cvt_pk_bf16_f32 v242, v132, v133
    v_cvt_pk_bf16_f32 v243, v134, v135
    buffer_store_dwordx4 v[240:243], v35, s[32:35], 0 offen offset:0 sc1
    v_pk_mul_f32 v[136:137], v[136:137], s[90:91]
    v_pk_mul_f32 v[138:139], v[138:139], s[90:91]
    v_pk_mul_f32 v[140:141], v[140:141], s[90:91]
    v_pk_mul_f32 v[142:143], v[142:143], s[90:91]
    v_exp_f32 v136, v136
    v_exp_f32 v137, v137
    v_exp_f32 v138, v138
    v_exp_f32 v139, v139
    v_exp_f32 v140, v140
    v_exp_f32 v141, v141
    v_exp_f32 v142, v142
    v_exp_f32 v143, v143
    v_pk_fma_f32 v[136:137], v[136:137], v[8:9], v[8:9]
    v_pk_fma_f32 v[138:139], v[138:139], v[8:9], v[8:9]
    v_pk_fma_f32 v[140:141], v[140:141], v[8:9], v[8:9]
    v_pk_fma_f32 v[142:143], v[142:143], v[8:9], v[8:9]
    v_rcp_f32 v136, v136
    v_rcp_f32 v137, v137
    v_rcp_f32 v138, v138
    v_rcp_f32 v139, v139
    v_rcp_f32 v140, v140
    v_rcp_f32 v141, v141
    v_rcp_f32 v142, v142
    v_rcp_f32 v143, v143
    v_pk_mul_f32 v[136:137], v[136:137], v[88:89]
    v_pk_mul_f32 v[138:139], v[138:139], v[90:91]
    v_pk_mul_f32 v[140:141], v[140:141], v[92:93]
    v_pk_mul_f32 v[142:143], v[142:143], v[94:95]
    v_cvt_pk_bf16_f32 v244, v136, v137
    v_cvt_pk_bf16_f32 v245, v138, v139
    v_cvt_pk_bf16_f32 v246, v140, v141
    v_cvt_pk_bf16_f32 v247, v142, v143
    buffer_store_dwordx4 v[244:247], v35, s[32:35], 0 offen offset:1024 sc1
    s_barrier
    ds_read_b128 v[52:55], v5 offset:32768
    ds_read_b128 v[56:59], v5 offset:33792
    s_mov_b64 exec, s[86:87]
    ds_read_b128 v[200:203], v5 offset:34816
    ds_read_b128 v[204:207], v5 offset:35840
    s_mov_b64 exec, -1
    s_waitcnt lgkmcnt(3)
    v_mfma_f32_32x32x16_bf16 v[176:191], v[52:55], v[248:251], v[224:239]
    s_waitcnt lgkmcnt(2)
    v_mfma_f32_32x32x16_bf16 v[160:175], v[56:59], v[252:255], v[224:239]
    ds_read_b128 v[52:55], v5 offset:28672
    s_nop 8
    v_exp_f32 v176, v176
    v_exp_f32 v177, v177
    s_add_u32 m0, s82, 98304
    s_add_u32 s79, s6, 32768
    buffer_load_dwordx4 v26, s[24:27], s79 offen offset:0 lds
    v_exp_f32 v178, v178
    v_exp_f32 v179, v179
    s_mov_b64 exec, s[88:89]
    ds_read_b128 v[192:195], v5 offset:34816
    ds_read_b128 v[196:199], v5 offset:35840
    s_mov_b64 exec, -1
    v_exp_f32 v180, v180
    v_exp_f32 v181, v181
    v_exp_f32 v182, v182
    v_exp_f32 v183, v183
    buffer_load_dwordx4 v27, s[24:27], s79 offen offset:1024 lds
    v_exp_f32 v184, v184
    v_cvt_pk_bf16_f32 v240, v176, v177
    v_cvt_pk_bf16_f32 v241, v178, v179
    v_cvt_pk_bf16_f32 v242, v180, v181
    v_cvt_pk_bf16_f32 v243, v182, v183
    v_exp_f32 v185, v185
    v_exp_f32 v186, v186
    v_exp_f32 v187, v187
    s_waitcnt lgkmcnt(4)
    v_mfma_f32_32x32x16_bf16 v[144:159], v[200:203], v[240:243], 0
    v_exp_f32 v188, v188
    v_exp_f32 v189, v189
    buffer_load_dwordx4 v28, s[24:27], s79 offen offset:2048 lds
    v_exp_f32 v190, v190
    v_exp_f32 v191, v191
    v_cvt_pk_bf16_f32 v244, v184, v185
    v_cvt_pk_bf16_f32 v245, v186, v187
    v_cvt_pk_bf16_f32 v246, v188, v189
    v_cvt_pk_bf16_f32 v247, v190, v191
    s_waitcnt lgkmcnt(0)
    v_mfma_f32_32x32x16_bf16 v[176:191], v[52:55], v[248:251], 0
    ds_read_b128 v[56:59], v5 offset:29696
    v_exp_f32 v160, v160
    v_exp_f32 v161, v161
    buffer_load_dwordx4 v29, s[24:27], s79 offen offset:3072 lds
    v_exp_f32 v162, v162
    v_exp_f32 v163, v163
    v_mfma_f32_32x32x16_bf16 v[144:159], v[204:207], v[244:247], v[144:159]
    s_cmp_ge_u32 s84, 1
    s_cselect_b64 exec, s[86:87], -1
    ds_read_b128 v[200:203], v5 offset:30720
    ds_read_b128 v[204:207], v5 offset:31744
    s_mov_b64 exec, -1
    v_exp_f32 v164, v164
    v_exp_f32 v165, v165
    s_add_u32 m0, s82, 81920
    s_add_u32 s79, s6, 65536
    buffer_load_dwordx4 v26, s[24:27], s79 offen offset:0 lds
    v_exp_f32 v166, v166
    v_exp_f32 v167, v167
    v_exp_f32 v168, v168
    v_cvt_pk_bf16_f32 v240, v160, v161
    v_cvt_pk_bf16_f32 v241, v162, v163
    v_cvt_pk_bf16_f32 v242, v164, v165
    v_cvt_pk_bf16_f32 v243, v166, v167
    v_exp_f32 v169, v169
    v_exp_f32 v170, v170
    v_exp_f32 v171, v171
    buffer_load_dwordx4 v27, s[24:27], s79 offen offset:1024 lds
    v_mfma_f32_32x32x16_bf16 v[128:143], v[192:195], v[240:243], 0
    v_exp_f32 v172, v172
    v_exp_f32 v173, v173
    v_exp_f32 v174, v174
    v_exp_f32 v175, v175
    v_cvt_pk_bf16_f32 v244, v168, v169
    v_cvt_pk_bf16_f32 v245, v170, v171
    v_cvt_pk_bf16_f32 v246, v172, v173
    v_cvt_pk_bf16_f32 v247, v174, v175
    s_waitcnt lgkmcnt(0)
    v_mfma_f32_32x32x16_bf16 v[160:175], v[56:59], v[252:255], 0
    ds_read_b128 v[52:55], v5 offset:24576
    v_exp_f32 v176, v176
    v_exp_f32 v177, v177
    buffer_load_dwordx4 v28, s[24:27], s79 offen offset:2048 lds
    v_exp_f32 v178, v178
    v_exp_f32 v179, v179
    v_mfma_f32_32x32x16_bf16 v[128:143], v[196:199], v[244:247], v[128:143]
    s_cmp_ge_u32 s84, 1
    s_cselect_b64 exec, s[88:89], -1
    ds_read_b128 v[192:195], v5 offset:30720
    ds_read_b128 v[196:199], v5 offset:31744
    s_mov_b64 exec, -1
    v_exp_f32 v180, v180
    v_exp_f32 v181, v181
    buffer_load_dwordx4 v29, s[24:27], s79 offen offset:3072 lds
    v_exp_f32 v182, v182
    v_exp_f32 v183, v183
    s_waitcnt vmcnt(8)
    v_mov_b32 v8, s51
    s_mov_b64 exec, 1
    buffer_atomic_add v16, v8, s[32:35], 0 offen sc1
    s_mov_b64 exec, -1
    s_lshl_b32 s78, s70, 7
    s_add_u32 s77, s52, s78
    v_mov_b32 v8, s77
    v_exp_f32 v184, v184
    v_cvt_pk_bf16_f32 v240, v176, v177
    v_cvt_pk_bf16_f32 v241, v178, v179
    v_cvt_pk_bf16_f32 v242, v180, v181
    v_cvt_pk_bf16_f32 v243, v182, v183
    v_exp_f32 v185, v185
    s_add_u32 m0, s82, 65536
    s_add_u32 s79, s6, 98304
    buffer_load_dwordx4 v26, s[24:27], s79 offen offset:0 lds
    v_exp_f32 v186, v186
    v_exp_f32 v187, v187
    v_mfma_f32_32x32x16_bf16 v[144:159], v[200:203], v[240:243], v[144:159]
    v_exp_f32 v188, v188
    v_exp_f32 v189, v189
    v_exp_f32 v190, v190
    v_exp_f32 v191, v191
    buffer_load_dwordx4 v27, s[24:27], s79 offen offset:1024 lds
    v_cvt_pk_bf16_f32 v244, v184, v185
    v_cvt_pk_bf16_f32 v245, v186, v187
    v_cvt_pk_bf16_f32 v246, v188, v189
    v_cvt_pk_bf16_f32 v247, v190, v191
    s_waitcnt lgkmcnt(0)
    v_mfma_f32_32x32x16_bf16 v[176:191], v[52:55], v[248:251], 0
    ds_read_b128 v[56:59], v5 offset:25600
    v_exp_f32 v160, v160
    v_exp_f32 v161, v161
    v_exp_f32 v162, v162
    v_exp_f32 v163, v163
    buffer_load_dwordx4 v28, s[24:27], s79 offen offset:2048 lds
    v_mfma_f32_32x32x16_bf16 v[144:159], v[204:207], v[244:247], v[144:159]
    s_cmp_ge_u32 s84, 2
    s_cselect_b64 exec, s[86:87], -1
    ds_read_b128 v[200:203], v5 offset:26624
    ds_read_b128 v[204:207], v5 offset:27648
    s_mov_b64 exec, -1
    v_exp_f32 v164, v164
    v_exp_f32 v165, v165
    s_waitcnt vmcnt(8)
    ds_read_b64_tr_b16 a[144:145], v30 offset:49152
    ds_read_b64_tr_b16 a[146:147], v30 offset:49664
    v_exp_f32 v166, v166
    v_exp_f32 v167, v167
    buffer_load_dwordx4 v29, s[24:27], s79 offen offset:3072 lds
    v_exp_f32 v168, v168
    v_cvt_pk_bf16_f32 v240, v160, v161
    v_cvt_pk_bf16_f32 v241, v162, v163
    v_cvt_pk_bf16_f32 v242, v164, v165
    v_cvt_pk_bf16_f32 v243, v166, v167
    v_exp_f32 v169, v169
    ds_read_b64_tr_b16 a[148:149], v31 offset:49152
    ds_read_b64_tr_b16 a[150:151], v31 offset:49664
    v_exp_f32 v170, v170
    v_exp_f32 v171, v171
    ds_read_b64_tr_b16 a[152:153], v32 offset:49152
    ds_read_b64_tr_b16 a[154:155], v32 offset:49664
    v_mfma_f32_32x32x16_bf16 v[128:143], v[192:195], v[240:243], v[128:143]
    v_exp_f32 v172, v172
    v_exp_f32 v173, v173
    s_add_u32 m0, s82, 49152
    s_add_u32 s79, s6, 131072
    buffer_load_dwordx4 v26, s[24:27], s79 offen offset:0 lds
    v_exp_f32 v174, v174
    v_exp_f32 v175, v175
    ds_read_b64_tr_b16 a[156:157], v33 offset:49152
    ds_read_b64_tr_b16 a[158:159], v33 offset:49664
    v_cvt_pk_bf16_f32 v244, v168, v169
    v_cvt_pk_bf16_f32 v245, v170, v171
    v_cvt_pk_bf16_f32 v246, v172, v173
    v_cvt_pk_bf16_f32 v247, v174, v175
    s_waitcnt lgkmcnt(8)
    v_mfma_f32_32x32x16_bf16 v[160:175], v[56:59], v[252:255], 0
    ds_read_b128 v[52:55], v5 offset:20480
    v_exp_f32 v176, v176
    v_exp_f32 v177, v177
    buffer_load_dwordx4 v27, s[24:27], s79 offen offset:1024 lds
    v_exp_f32 v178, v178
    v_exp_f32 v179, v179
    v_mfma_f32_32x32x16_bf16 v[128:143], v[196:199], v[244:247], v[128:143]
    s_cmp_ge_u32 s84, 2
    s_cselect_b64 exec, s[88:89], -1
    ds_read_b128 v[192:195], v5 offset:26624
    ds_read_b128 v[196:199], v5 offset:27648
    s_mov_b64 exec, -1
    v_exp_f32 v180, v180
    v_exp_f32 v181, v181
    buffer_load_dwordx4 v28, s[24:27], s79 offen offset:2048 lds
    v_exp_f32 v182, v182
    v_exp_f32 v183, v183
    s_waitcnt vmcnt(8)
    ds_read_b64_tr_b16 a[160:161], v30 offset:32768
    ds_read_b64_tr_b16 a[162:163], v30 offset:33280
    v_exp_f32 v184, v184
    v_cvt_pk_bf16_f32 v240, v176, v177
    v_cvt_pk_bf16_f32 v241, v178, v179
    v_cvt_pk_bf16_f32 v242, v180, v181
    v_cvt_pk_bf16_f32 v243, v182, v183
    v_exp_f32 v185, v185
    buffer_load_dwordx4 v29, s[24:27], s79 offen offset:3072 lds
    v_exp_f32 v186, v186
    v_exp_f32 v187, v187
    s_waitcnt lgkmcnt(5)
    v_mfma_f32_32x32x16_bf16 v[144:159], v[200:203], v[240:243], v[144:159]
    v_exp_f32 v188, v188
    v_exp_f32 v189, v189
    ds_read_b64_tr_b16 a[164:165], v31 offset:32768
    ds_read_b64_tr_b16 a[166:167], v31 offset:33280
    v_exp_f32 v190, v190
    v_exp_f32 v191, v191
    s_add_u32 m0, s82, 98304
    s_add_u32 s79, s6, 163840
    buffer_load_dwordx4 v26, s[24:27], s79 offen offset:0 lds
    v_cvt_pk_bf16_f32 v244, v184, v185
    v_cvt_pk_bf16_f32 v245, v186, v187
    v_cvt_pk_bf16_f32 v246, v188, v189
    v_cvt_pk_bf16_f32 v247, v190, v191
    ds_read_b64_tr_b16 a[168:169], v32 offset:32768
    ds_read_b64_tr_b16 a[170:171], v32 offset:33280
    s_waitcnt lgkmcnt(6)
    v_mfma_f32_32x32x16_bf16 v[176:191], v[52:55], v[248:251], 0
    ds_read_b128 v[56:59], v5 offset:21504
    v_exp_f32 v160, v160
    v_exp_f32 v161, v161
    buffer_load_dwordx4 v27, s[24:27], s79 offen offset:1024 lds
    v_exp_f32 v162, v162
    v_exp_f32 v163, v163
    ds_read_b64_tr_b16 a[172:173], v33 offset:32768
    ds_read_b64_tr_b16 a[174:175], v33 offset:33280
    v_mfma_f32_32x32x16_bf16 v[144:159], v[204:207], v[244:247], v[144:159]
    s_cmp_ge_u32 s84, 3
    s_cselect_b64 exec, s[86:87], -1
    ds_read_b128 v[200:203], v5 offset:22528
    ds_read_b128 v[204:207], v5 offset:23552
    s_mov_b64 exec, -1
    v_exp_f32 v164, v164
    v_exp_f32 v165, v165
    buffer_load_dwordx4 v28, s[24:27], s79 offen offset:2048 lds
    v_exp_f32 v166, v166
    v_exp_f32 v167, v167
    s_waitcnt vmcnt(7)
    ds_read_b64_tr_b16 a[0:1], v30 offset:16384
    ds_read_b64_tr_b16 a[2:3], v30 offset:16896
    v_exp_f32 v168, v168
    v_cvt_pk_bf16_f32 v240, v160, v161
    v_cvt_pk_bf16_f32 v241, v162, v163
    v_cvt_pk_bf16_f32 v242, v164, v165
    v_cvt_pk_bf16_f32 v243, v166, v167
    v_exp_f32 v169, v169
    buffer_load_dwordx4 v29, s[24:27], s79 offen offset:3072 lds
    v_exp_f32 v170, v170
    v_exp_f32 v171, v171
    s_waitcnt lgkmcnt(4)
    v_mfma_f32_32x32x16_bf16 v[128:143], v[192:195], v[240:243], v[128:143]
    v_exp_f32 v172, v172
    v_exp_f32 v173, v173
    ds_read_b64_tr_b16 a[4:5], v31 offset:16384
    ds_read_b64_tr_b16 a[6:7], v31 offset:16896
    v_exp_f32 v174, v174
    v_exp_f32 v175, v175
    s_add_u32 m0, s82, 81920
    s_add_u32 s79, s6, 196608
    buffer_load_dwordx4 v26, s[24:27], s79 offen offset:0 lds
    v_cvt_pk_bf16_f32 v244, v168, v169
    v_cvt_pk_bf16_f32 v245, v170, v171
    v_cvt_pk_bf16_f32 v246, v172, v173
    v_cvt_pk_bf16_f32 v247, v174, v175
    ds_read_b64_tr_b16 a[8:9], v32 offset:16384
    ds_read_b64_tr_b16 a[10:11], v32 offset:16896
    s_waitcnt lgkmcnt(6)
    v_mfma_f32_32x32x16_bf16 v[160:175], v[56:59], v[252:255], 0
    ds_read_b128 v[52:55], v5 offset:16384
    v_exp_f32 v176, v176
    v_exp_f32 v177, v177
    buffer_load_dwordx4 v27, s[24:27], s79 offen offset:1024 lds
    v_exp_f32 v178, v178
    v_exp_f32 v179, v179
    ds_read_b64_tr_b16 a[12:13], v33 offset:16384
    ds_read_b64_tr_b16 a[14:15], v33 offset:16896
    v_mfma_f32_32x32x16_bf16 v[128:143], v[196:199], v[244:247], v[128:143]
    s_cmp_ge_u32 s84, 3
    s_cselect_b64 exec, s[88:89], -1
    ds_read_b128 v[192:195], v5 offset:22528
    ds_read_b128 v[196:199], v5 offset:23552
    s_mov_b64 exec, -1
    v_exp_f32 v180, v180
    v_exp_f32 v181, v181
    buffer_load_dwordx4 v28, s[24:27], s79 offen offset:2048 lds
    v_exp_f32 v182, v182
    v_exp_f32 v183, v183
    v_exp_f32 v184, v184
    v_cvt_pk_bf16_f32 v240, v176, v177
    v_cvt_pk_bf16_f32 v241, v178, v179
    v_cvt_pk_bf16_f32 v242, v180, v181
    v_cvt_pk_bf16_f32 v243, v182, v183
    v_exp_f32 v185, v185
    s_waitcnt vmcnt(7)
    ds_read_b64_tr_b16 a[16:17], v30 offset:0
    ds_read_b64_tr_b16 a[18:19], v30 offset:512
    v_exp_f32 v186, v186
    v_exp_f32 v187, v187
    buffer_load_dwordx4 v29, s[24:27], s79 offen offset:3072 lds
    v_mfma_f32_32x32x16_bf16 v[144:159], v[200:203], v[240:243], v[144:159]
    v_exp_f32 v188, v188
    v_exp_f32 v189, v189
    s_waitcnt lgkmcnt(4)
    v_exp_f32 v190, v190
    v_exp_f32 v191, v191
    ds_read_b64_tr_b16 a[20:21], v31 offset:0
    ds_read_b64_tr_b16 a[22:23], v31 offset:512
    v_cvt_pk_bf16_f32 v244, v184, v185
    v_cvt_pk_bf16_f32 v245, v186, v187
    v_cvt_pk_bf16_f32 v246, v188, v189
    v_cvt_pk_bf16_f32 v247, v190, v191
    s_add_u32 m0, s82, 65536
    s_add_u32 s79, s6, 229376
    buffer_load_dwordx4 v26, s[24:27], s79 offen offset:0 lds
    s_waitcnt lgkmcnt(4)
    v_mfma_f32_32x32x16_bf16 v[176:191], v[52:55], v[248:251], 0
    ds_read_b128 v[56:59], v5 offset:17408
    v_exp_f32 v160, v160
    v_exp_f32 v161, v161
    ds_read_b64_tr_b16 a[24:25], v32 offset:0
    ds_read_b64_tr_b16 a[26:27], v32 offset:512
    v_exp_f32 v162, v162
    v_exp_f32 v163, v163
    buffer_load_dwordx4 v27, s[24:27], s79 offen offset:1024 lds
    v_mfma_f32_32x32x16_bf16 v[144:159], v[204:207], v[244:247], v[144:159]
    s_cmp_ge_u32 s84, 4
    s_cselect_b64 exec, s[86:87], -1
    ds_read_b128 v[200:203], v5 offset:18432
    ds_read_b128 v[204:207], v5 offset:19456
    s_mov_b64 exec, -1
    v_exp_f32 v164, v164
    v_exp_f32 v165, v165
    ds_read_b64_tr_b16 a[28:29], v33 offset:0
    ds_read_b64_tr_b16 a[30:31], v33 offset:512
    v_exp_f32 v166, v166
    v_exp_f32 v167, v167
    buffer_load_dwordx4 v28, s[24:27], s79 offen offset:2048 lds
    v_exp_f32 v168, v168
    v_cvt_pk_bf16_f32 v240, v160, v161
    v_cvt_pk_bf16_f32 v241, v162, v163
    v_cvt_pk_bf16_f32 v242, v164, v165
    v_cvt_pk_bf16_f32 v243, v166, v167
    v_exp_f32 v169, v169
    s_waitcnt vmcnt(7)
    ds_read_b64_tr_b16 a[32:33], v30 offset:49152
    ds_read_b64_tr_b16 a[34:35], v30 offset:49664
    v_exp_f32 v170, v170
    v_exp_f32 v171, v171
    buffer_load_dwordx4 v29, s[24:27], s79 offen offset:3072 lds
    v_mfma_f32_32x32x16_bf16 v[128:143], v[192:195], v[240:243], v[128:143]
    v_exp_f32 v172, v172
    v_exp_f32 v173, v173
    s_waitcnt lgkmcnt(2)
    v_exp_f32 v174, v174
    v_exp_f32 v175, v175
    ds_read_b64_tr_b16 a[36:37], v31 offset:49152
    ds_read_b64_tr_b16 a[38:39], v31 offset:49664
    v_cvt_pk_bf16_f32 v244, v168, v169
    v_cvt_pk_bf16_f32 v245, v170, v171
    v_cvt_pk_bf16_f32 v246, v172, v173
    v_cvt_pk_bf16_f32 v247, v174, v175
    s_add_u32 m0, s82, 49152
    s_add_u32 s79, s6, 262144
    buffer_load_dwordx4 v26, s[24:27], s79 offen offset:0 lds
    v_mfma_f32_32x32x16_bf16 v[160:175], v[56:59], v[252:255], 0
    ds_read_b128 v[52:55], v5 offset:12288
    v_exp_f32 v176, v176
    v_exp_f32 v177, v177
    ds_read_b64_tr_b16 a[40:41], v32 offset:49152
    ds_read_b64_tr_b16 a[42:43], v32 offset:49664
    v_exp_f32 v178, v178
    v_exp_f32 v179, v179
    buffer_load_dwordx4 v27, s[24:27], s79 offen offset:1024 lds
    v_mfma_f32_32x32x16_bf16 v[128:143], v[196:199], v[244:247], v[128:143]
    s_cmp_ge_u32 s84, 4
    s_cselect_b64 exec, s[88:89], -1
    ds_read_b128 v[192:195], v5 offset:18432
    ds_read_b128 v[196:199], v5 offset:19456
    s_mov_b64 exec, -1
    v_exp_f32 v180, v180
    v_exp_f32 v181, v181
    ds_read_b64_tr_b16 a[44:45], v33 offset:49152
    ds_read_b64_tr_b16 a[46:47], v33 offset:49664
    v_exp_f32 v182, v182
    v_exp_f32 v183, v183
    buffer_load_dwordx4 v28, s[24:27], s79 offen offset:2048 lds
    v_exp_f32 v184, v184
    v_cvt_pk_bf16_f32 v240, v176, v177
    v_cvt_pk_bf16_f32 v241, v178, v179
    v_cvt_pk_bf16_f32 v242, v180, v181
    v_cvt_pk_bf16_f32 v243, v182, v183
    v_exp_f32 v185, v185
    v_exp_f32 v186, v186
    v_exp_f32 v187, v187
    s_waitcnt vmcnt(7)
    ds_read_b64_tr_b16 a[48:49], v30 offset:32768
    ds_read_b64_tr_b16 a[50:51], v30 offset:33280
    v_mfma_f32_32x32x16_bf16 v[144:159], v[200:203], v[240:243], v[144:159]
    v_exp_f32 v188, v188
    v_exp_f32 v189, v189
    buffer_load_dwordx4 v29, s[24:27], s79 offen offset:3072 lds
    v_exp_f32 v190, v190
    v_exp_f32 v191, v191
    s_waitcnt lgkmcnt(2)
    v_cvt_pk_bf16_f32 v244, v184, v185
    v_cvt_pk_bf16_f32 v245, v186, v187
    v_cvt_pk_bf16_f32 v246, v188, v189
    v_cvt_pk_bf16_f32 v247, v190, v191
    ds_read_b64_tr_b16 a[52:53], v31 offset:32768
    ds_read_b64_tr_b16 a[54:55], v31 offset:33280
    v_mfma_f32_32x32x16_bf16 v[176:191], v[52:55], v[248:251], 0
    ds_read_b128 v[56:59], v5 offset:13312
    v_exp_f32 v160, v160
    v_exp_f32 v161, v161
    s_add_u32 m0, s82, 98304
    s_add_u32 s79, s6, 294912
    buffer_load_dwordx4 v26, s[24:27], s79 offen offset:0 lds
    v_exp_f32 v162, v162
    v_exp_f32 v163, v163
    ds_read_b64_tr_b16 a[56:57], v32 offset:32768
    ds_read_b64_tr_b16 a[58:59], v32 offset:33280
    v_mfma_f32_32x32x16_bf16 v[144:159], v[204:207], v[244:247], v[144:159]
    s_cmp_ge_u32 s84, 5
    s_cselect_b64 exec, s[86:87], -1
    ds_read_b128 v[200:203], v5 offset:14336
    ds_read_b128 v[204:207], v5 offset:15360
    s_mov_b64 exec, -1
    v_exp_f32 v164, v164
    v_exp_f32 v165, v165
    buffer_load_dwordx4 v27, s[24:27], s79 offen offset:1024 lds
    v_exp_f32 v166, v166
    v_exp_f32 v167, v167
    ds_read_b64_tr_b16 a[60:61], v33 offset:32768
    ds_read_b64_tr_b16 a[62:63], v33 offset:33280
    v_exp_f32 v168, v168
    v_cvt_pk_bf16_f32 v240, v160, v161
    v_cvt_pk_bf16_f32 v241, v162, v163
    v_cvt_pk_bf16_f32 v242, v164, v165
    v_cvt_pk_bf16_f32 v243, v166, v167
    v_exp_f32 v169, v169
    v_exp_f32 v170, v170
    v_exp_f32 v171, v171
    buffer_load_dwordx4 v28, s[24:27], s79 offen offset:2048 lds
    v_mfma_f32_32x32x16_bf16 v[128:143], v[192:195], v[240:243], v[128:143]
    v_exp_f32 v172, v172
    v_exp_f32 v173, v173
    s_waitcnt vmcnt(7)
    ds_read_b64_tr_b16 a[64:65], v30 offset:16384
    ds_read_b64_tr_b16 a[66:67], v30 offset:16896
    v_exp_f32 v174, v174
    v_exp_f32 v175, v175
    ds_read_b64_tr_b16 a[68:69], v31 offset:16384
    ds_read_b64_tr_b16 a[70:71], v31 offset:16896
    v_cvt_pk_bf16_f32 v244, v168, v169
    v_cvt_pk_bf16_f32 v245, v170, v171
    v_cvt_pk_bf16_f32 v246, v172, v173
    v_cvt_pk_bf16_f32 v247, v174, v175
    buffer_load_dword v9, v8, s[32:35], 0 offen sc1
    s_waitcnt lgkmcnt(6)
    v_mfma_f32_32x32x16_bf16 v[160:175], v[56:59], v[252:255], 0
    ds_read_b128 v[52:55], v5 offset:8192
    v_exp_f32 v176, v176
    v_exp_f32 v177, v177
    buffer_load_dwordx4 v29, s[24:27], s79 offen offset:3072 lds
    v_exp_f32 v178, v178
    v_exp_f32 v179, v179
    s_waitcnt lgkmcnt(5)
    v_mfma_f32_32x32x16_bf16 v[128:143], v[196:199], v[244:247], v[128:143]
    s_cmp_ge_u32 s84, 5
    s_cselect_b64 exec, s[88:89], -1
    ds_read_b128 v[192:195], v5 offset:14336
    ds_read_b128 v[196:199], v5 offset:15360
    s_mov_b64 exec, -1
    v_exp_f32 v180, v180
    v_exp_f32 v181, v181
    s_add_u32 m0, s82, 81920
    s_add_u32 s79, s6, 327680
    buffer_load_dwordx4 v26, s[24:27], s79 offen offset:0 lds
    v_exp_f32 v182, v182
    v_exp_f32 v183, v183
    ds_read_b64_tr_b16 a[72:73], v32 offset:16384
    ds_read_b64_tr_b16 a[74:75], v32 offset:16896
    v_exp_f32 v184, v184
    v_cvt_pk_bf16_f32 v240, v176, v177
    v_cvt_pk_bf16_f32 v241, v178, v179
    v_cvt_pk_bf16_f32 v242, v180, v181
    v_cvt_pk_bf16_f32 v243, v182, v183
    v_exp_f32 v185, v185
    buffer_load_dwordx4 v27, s[24:27], s79 offen offset:1024 lds
    v_exp_f32 v186, v186
    v_exp_f32 v187, v187
    ds_read_b64_tr_b16 a[76:77], v33 offset:16384
    ds_read_b64_tr_b16 a[78:79], v33 offset:16896
    v_mfma_f32_32x32x16_bf16 v[144:159], v[200:203], v[240:243], v[144:159]
    v_exp_f32 v188, v188
    v_exp_f32 v189, v189
    s_waitcnt vmcnt(7)
    ds_read_b64_tr_b16 a[80:81], v30 offset:0
    ds_read_b64_tr_b16 a[82:83], v30 offset:512
    v_exp_f32 v190, v190
    v_exp_f32 v191, v191
    buffer_load_dwordx4 v28, s[24:27], s79 offen offset:2048 lds
    v_cvt_pk_bf16_f32 v244, v184, v185
    v_cvt_pk_bf16_f32 v245, v186, v187
    v_cvt_pk_bf16_f32 v246, v188, v189
    v_cvt_pk_bf16_f32 v247, v190, v191
    ds_read_b64_tr_b16 a[84:85], v31 offset:0
    ds_read_b64_tr_b16 a[86:87], v31 offset:512
    s_waitcnt lgkmcnt(8)
    v_mfma_f32_32x32x16_bf16 v[176:191], v[52:55], v[248:251], 0
    ds_read_b128 v[56:59], v5 offset:9216
    v_exp_f32 v160, v160
    v_exp_f32 v161, v161
    ds_read_b64_tr_b16 a[88:89], v32 offset:0
    ds_read_b64_tr_b16 a[90:91], v32 offset:512
    v_exp_f32 v162, v162
    v_exp_f32 v163, v163
    buffer_load_dwordx4 v29, s[24:27], s79 offen offset:3072 lds
    v_mfma_f32_32x32x16_bf16 v[144:159], v[204:207], v[244:247], v[144:159]
    s_cmp_ge_u32 s84, 6
    s_cselect_b64 exec, s[86:87], -1
    ds_read_b128 v[200:203], v5 offset:10240
    ds_read_b128 v[204:207], v5 offset:11264
    s_mov_b64 exec, -1
    v_exp_f32 v164, v164
    v_exp_f32 v165, v165
    ds_read_b64_tr_b16 a[92:93], v33 offset:0
    ds_read_b64_tr_b16 a[94:95], v33 offset:512
    v_exp_f32 v166, v166
    v_exp_f32 v167, v167
    v_exp_f32 v168, v168
    v_cvt_pk_bf16_f32 v240, v160, v161
    v_cvt_pk_bf16_f32 v241, v162, v163
    v_cvt_pk_bf16_f32 v242, v164, v165
    v_cvt_pk_bf16_f32 v243, v166, v167
    v_exp_f32 v169, v169
    v_exp_f32 v170, v170
    v_exp_f32 v171, v171
    v_mfma_f32_32x32x16_bf16 v[128:143], v[192:195], v[240:243], v[128:143]
    v_exp_f32 v172, v172
    v_exp_f32 v173, v173
    s_waitcnt lgkmcnt(0)
    v_exp_f32 v174, v174
    v_exp_f32 v175, v175
    s_add_u32 m0, s82, 49152
    s_add_u32 s79, s7, 98304
    buffer_load_dwordx4 v26, s[28:31], s79 offen offset:0 lds
    v_cvt_pk_bf16_f32 v244, v168, v169
    v_cvt_pk_bf16_f32 v245, v170, v171
    v_cvt_pk_bf16_f32 v246, v172, v173
    v_cvt_pk_bf16_f32 v247, v174, v175
    v_mfma_f32_32x32x16_bf16 v[160:175], v[56:59], v[252:255], 0
    ds_read_b128 v[52:55], v5 offset:4096
    v_exp_f32 v176, v176
    v_exp_f32 v177, v177
    v_exp_f32 v178, v178
    v_exp_f32 v179, v179
    buffer_load_dwordx4 v27, s[28:31], s79 offen offset:1024 lds
    v_mfma_f32_32x32x16_bf16 v[128:143], v[196:199], v[244:247], v[128:143]
    s_cmp_ge_u32 s84, 6
    s_cselect_b64 exec, s[88:89], -1
    ds_read_b128 v[192:195], v5 offset:10240
    ds_read_b128 v[196:199], v5 offset:11264
    s_mov_b64 exec, -1
    v_exp_f32 v180, v180
    v_exp_f32 v181, v181
    v_exp_f32 v182, v182
    v_exp_f32 v183, v183
    buffer_load_dwordx4 v28, s[28:31], s79 offen offset:2048 lds
    v_exp_f32 v184, v184
    v_cvt_pk_bf16_f32 v240, v176, v177
    v_cvt_pk_bf16_f32 v241, v178, v179
L_pad_3:
    s_cbranch_execz L_warm_back
    v_cvt_pk_bf16_f32 v242, v180, v181
    v_cvt_pk_bf16_f32 v243, v182, v183
    v_exp_f32 v185, v185
    v_exp_f32 v186, v186
    v_exp_f32 v187, v187
    v_mfma_f32_32x32x16_bf16 v[144:159], v[200:203], v[240:243], v[144:159]
    v_exp_f32 v188, v188
    v_exp_f32 v189, v189
    buffer_load_dwordx4 v29, s[28:31], s79 offen offset:3072 lds
    v_exp_f32 v190, v190
    v_exp_f32 v191, v191
    s_waitcnt vmcnt(9)
    v_cmp_ne_u32 vcc, 8, v9
    s_mov_b32 s93, 0
    s_cbranch_vccz L_h_ok
L_h_retry:
    buffer_load_dword v9, v8, s[32:35], 0 offen sc1
    s_add_u32 s93, s93, 1
    s_cmp_ge_u32 s93, 0x40000
    s_waitcnt vmcnt(0)
    v_cmp_ne_u32 vcc, 8, v9
    s_cbranch_scc1 L_h_ok
    s_cbranch_vccnz L_h_retry
L_h_ok:
    v_cvt_pk_bf16_f32 v244, v184, v185
    v_cvt_pk_bf16_f32 v245, v186, v187
    v_cvt_pk_bf16_f32 v246, v188, v189
    v_cvt_pk_bf16_f32 v247, v190, v191
    s_mov_b32 s76, 0
    buffer_load_dwordx4 a[96:99], v40, s[32:35], s76 offen offset:0 sc1
    s_waitcnt lgkmcnt(0)
    v_mfma_f32_32x32x16_bf16 v[176:191], v[52:55], v[248:251], 0
    ds_read_b128 v[56:59], v5 offset:5120
    v_exp_f32 v160, v160
    v_exp_f32 v161, v161
    v_exp_f32 v162, v162
    v_exp_f32 v163, v163
    v_mfma_f32_32x32x16_bf16 v[144:159], v[204:207], v[244:247], v[144:159]
    s_cmp_ge_u32 s84, 7
    s_cselect_b64 exec, s[86:87], -1
    ds_read_b128 v[200:203], v5 offset:6144
    ds_read_b128 v[204:207], v5 offset:7168
    s_mov_b64 exec, -1
    v_exp_f32 v164, v164
    v_exp_f32 v165, v165
    buffer_load_dwordx4 a[100:103], v41, s[32:35], s76 offen offset:0 sc1
    v_exp_f32 v166, v166
    v_exp_f32 v167, v167
    v_exp_f32 v168, v168
    v_cvt_pk_bf16_f32 v240, v160, v161
    v_cvt_pk_bf16_f32 v241, v162, v163
    v_cvt_pk_bf16_f32 v242, v164, v165
    v_cvt_pk_bf16_f32 v243, v166, v167
    v_exp_f32 v169, v169
    v_exp_f32 v170, v170
    v_exp_f32 v171, v171
    v_mfma_f32_32x32x16_bf16 v[128:143], v[192:195], v[240:243], v[128:143]
    v_exp_f32 v172, v172
    v_exp_f32 v173, v173
    buffer_load_dwordx4 a[104:107], v42, s[32:35], s76 offen offset:0 sc1
    v_exp_f32 v174, v174
    v_exp_f32 v175, v175
    v_cvt_pk_bf16_f32 v244, v168, v169
    v_cvt_pk_bf16_f32 v245, v170, v171
    v_cvt_pk_bf16_f32 v246, v172, v173
    v_cvt_pk_bf16_f32 v247, v174, v175
    s_waitcnt lgkmcnt(0)
    v_mfma_f32_32x32x16_bf16 v[160:175], v[56:59], v[252:255], 0
    ds_read_b128 v[52:55], v5 offset:0
    v_exp_f32 v176, v176
    v_exp_f32 v177, v177
    v_exp_f32 v178, v178
    v_exp_f32 v179, v179
    buffer_load_dwordx4 a[108:111], v43, s[32:35], s76 offen offset:0 sc1
    v_mfma_f32_32x32x16_bf16 v[128:143], v[196:199], v[244:247], v[128:143]
    s_cmp_ge_u32 s84, 7
    s_cselect_b64 exec, s[88:89], -1
    ds_read_b128 v[192:195], v5 offset:6144
    ds_read_b128 v[196:199], v5 offset:7168
    s_mov_b64 exec, -1
    v_exp_f32 v180, v180
    v_exp_f32 v181, v181
    v_exp_f32 v182, v182
    v_exp_f32 v183, v183
    v_exp_f32 v184, v184
    v_cvt_pk_bf16_f32 v240, v176, v177
    v_cvt_pk_bf16_f32 v241, v178, v179
    v_cvt_pk_bf16_f32 v242, v180, v181
    v_cvt_pk_bf16_f32 v243, v182, v183
    v_exp_f32 v185, v185
    buffer_load_dwordx4 a[112:115], v40, s[32:35], s76 offen offset:2048 sc1
    v_exp_f32 v186, v186
    v_exp_f32 v187, v187
    v_mfma_f32_32x32x16_bf16 v[144:159], v[200:203], v[240:243], v[144:159]
    v_exp_f32 v188, v188
    v_exp_f32 v189, v189
    v_exp_f32 v190, v190
    v_exp_f32 v191, v191
    v_cvt_pk_bf16_f32 v244, v184, v185
    v_cvt_pk_bf16_f32 v245, v186, v187
    v_cvt_pk_bf16_f32 v246, v188, v189
    v_cvt_pk_bf16_f32 v247, v190, v191
    buffer_load_dwordx4 a[116:119], v41, s[32:35], s76 offen offset:2048 sc1
    s_waitcnt lgkmcnt(0)
    v_mfma_f32_32x32x16_bf16 v[176:191], v[52:55], v[248:251], v[208:223]
    ds_read_b128 v[56:59], v5 offset:1024
    v_exp_f32 v160, v160
    v_exp_f32 v161, v161
    v_exp_f32 v162, v162
    v_exp_f32 v163, v163
    v_mfma_f32_32x32x16_bf16 v[144:159], v[204:207], v[244:247], v[144:159]
    s_cmp_ge_u32 s84, 8
    s_cselect_b64 exec, s[86:87], -1
    ds_read_b128 v[200:203], v5 offset:2048
    ds_read_b128 v[204:207], v5 offset:3072
    s_mov_b64 exec, -1
    v_exp_f32 v164, v164
    v_exp_f32 v165, v165
    buffer_load_dwordx4 a[120:123], v42, s[32:35], s76 offen offset:2048 sc1
    v_exp_f32 v166, v166
    v_exp_f32 v167, v167
    v_exp_f32 v168, v168
    v_cvt_pk_bf16_f32 v240, v160, v161
    v_cvt_pk_bf16_f32 v241, v162, v163
    v_cvt_pk_bf16_f32 v242, v164, v165
    v_cvt_pk_bf16_f32 v243, v166, v167
    v_exp_f32 v169, v169
    v_exp_f32 v170, v170
    v_exp_f32 v171, v171
    v_mfma_f32_32x32x16_bf16 v[128:143], v[192:195], v[240:243], v[128:143]
    v_exp_f32 v172, v172
    v_exp_f32 v173, v173
    buffer_load_dwordx4 a[124:127], v43, s[32:35], s76 offen offset:2048 sc1
    v_exp_f32 v174, v174
    v_exp_f32 v175, v175
    v_cvt_pk_bf16_f32 v244, v168, v169
    v_cvt_pk_bf16_f32 v245, v170, v171
    v_cvt_pk_bf16_f32 v246, v172, v173
    v_cvt_pk_bf16_f32 v247, v174, v175
    s_waitcnt lgkmcnt(0)
    v_mfma_f32_32x32x16_bf16 v[160:175], v[56:59], v[252:255], v[208:223]
    v_exp_f32 v176, v176
    v_exp_f32 v177, v177
    v_exp_f32 v178, v178
    v_exp_f32 v179, v179
    s_mov_b32 s76, 4096
    buffer_load_dwordx4 a[176:179], v40, s[32:35], s76 offen offset:0 sc1
    v_mfma_f32_32x32x16_bf16 v[128:143], v[196:199], v[244:247], v[128:143]
    s_cmp_ge_u32 s84, 8
    s_cselect_b64 exec, s[88:89], -1
    ds_read_b128 v[192:195], v5 offset:2048
    ds_read_b128 v[196:199], v5 offset:3072
    s_mov_b64 exec, -1
    v_exp_f32 v180, v180
    v_exp_f32 v181, v181
    v_exp_f32 v182, v182
    v_exp_f32 v183, v183
    v_exp_f32 v184, v184
    v_cvt_pk_bf16_f32 v240, v176, v177
    v_cvt_pk_bf16_f32 v241, v178, v179
    v_cvt_pk_bf16_f32 v242, v180, v181
    v_cvt_pk_bf16_f32 v243, v182, v183
    v_exp_f32 v185, v185
    buffer_load_dwordx4 a[180:183], v41, s[32:35], s76 offen offset:0 sc1
    v_exp_f32 v186, v186
    v_exp_f32 v187, v187
    v_mfma_f32_32x32x16_bf16 v[144:159], v[200:203], v[240:243], v[144:159]
    v_exp_f32 v188, v188
    v_exp_f32 v189, v189
    v_exp_f32 v190, v190
    v_exp_f32 v191, v191
    v_cvt_pk_bf16_f32 v244, v184, v185
    v_cvt_pk_bf16_f32 v245, v186, v187
    v_cvt_pk_bf16_f32 v246, v188, v189
    v_cvt_pk_bf16_f32 v247, v190, v191
    buffer_load_dwordx4 a[184:187], v42, s[32:35], s76 offen offset:0 sc1
    s_waitcnt lgkmcnt(0)
    v_exp_f32 v160, v160
    v_exp_f32 v161, v161
    v_exp_f32 v162, v162
    v_exp_f32 v163, v163
    v_mfma_f32_32x32x16_bf16 v[144:159], v[204:207], v[244:247], v[144:159]
    v_exp_f32 v164, v164
    v_exp_f32 v165, v165
    v_exp_f32 v166, v166
    v_exp_f32 v167, v167
    buffer_load_dwordx4 a[188:191], v43, s[32:35], s76 offen offset:0 sc1
    v_exp_f32 v168, v168
    v_cvt_pk_bf16_f32 v240, v160, v161
    v_cvt_pk_bf16_f32 v241, v162, v163
    v_cvt_pk_bf16_f32 v242, v164, v165
    v_cvt_pk_bf16_f32 v243, v166, v167
    v_exp_f32 v169, v169
    v_exp_f32 v170, v170
    v_exp_f32 v171, v171
    v_mfma_f32_32x32x16_bf16 v[128:143], v[192:195], v[240:243], v[128:143]
    v_exp_f32 v172, v172
    v_exp_f32 v173, v173
    buffer_load_dwordx4 a[192:195], v40, s[32:35], s76 offen offset:2048 sc1
    v_exp_f32 v174, v174
    v_exp_f32 v175, v175
    v_cvt_pk_bf16_f32 v244, v168, v169
    v_cvt_pk_bf16_f32 v245, v170, v171
    v_cvt_pk_bf16_f32 v246, v172, v173
    v_cvt_pk_bf16_f32 v247, v174, v175
    v_add_u32 v10, s56, v11
    s_nop 0
    v_mfma_f32_32x32x16_bf16 v[128:143], v[196:199], v[244:247], v[128:143]
    v_max3_f32 v1, abs(v144), abs(v145), abs(v146)
    v_max3_f32 v1, v1, abs(v147), abs(v148)
    v_max3_f32 v1, v1, abs(v149), abs(v150)
    s_nop 8
    v_max3_f32 v1, v1, abs(v151), abs(v136)
    v_max3_f32 v1, v1, abs(v137), abs(v138)
    v_max3_f32 v1, v1, abs(v139), abs(v140)
    v_max3_f32 v1, v1, abs(v141), abs(v142)
    v_max_f32 v2, v152, v128
    v_mul_f32 v2, 0x70000000, v2
    v_max3_f32 v1, v1, abs(v143), v2
    v_min_f32 v3, v152, v128
    v_add_f32 v2, v152, v128
    v_cmp_nlt_f32 vcc, 0x30800000, v3
    s_nop 0
    s_mov_b64 s[90:91], vcc
    v_cmp_nlt_f32 vcc, 0, v2
    s_nop 0
    s_or_b64 s[90:91], s[90:91], vcc
    v_cmp_ngt_f32 vcc, 0x7f000000, v1
    s_nop 0
    s_or_b64 vcc, s[90:91], vcc
    s_cbranch_vccnz L_slow
L_slow_back:
    v_rcp_f32 v176, v152
    v_rcp_f32 v178, v128
    v_mul_f32 v176, v6, v176
    v_mul_f32 v178, v6, v178
    v_pk_mul_f32 v[144:145], v[144:145], v[176:177] op_sel_hi:[1,0]
    v_pk_mul_f32 v[146:147], v[146:147], v[176:177] op_sel_hi:[1,0]
    v_pk_mul_f32 v[148:149], v[148:149], v[176:177] op_sel_hi:[1,0]
    v_pk_mul_f32 v[150:151], v[150:151], v[176:177] op_sel_hi:[1,0]
    v_cvt_pk_bf16_f32 v240, v144, v145
    v_cvt_pk_bf16_f32 v241, v146, v147
    v_cvt_pk_bf16_f32 v242, v148, v149
    v_cvt_pk_bf16_f32 v243, v150, v151
    buffer_store_dwordx4 v[240:243], v10, s[32:35], 0 offen offset:0 sc1
    v_pk_mul_f32 v[136:137], v[136:137], v[178:179] op_sel_hi:[1,0]
    v_pk_mul_f32 v[138:139], v[138:139], v[178:179] op_sel_hi:[1,0]
    v_pk_mul_f32 v[140:141], v[140:141], v[178:179] op_sel_hi:[1,0]
    v_pk_mul_f32 v[142:143], v[142:143], v[178:179] op_sel_hi:[1,0]
    v_cvt_pk_bf16_f32 v244, v136, v137
    v_cvt_pk_bf16_f32 v245, v138, v139
    v_cvt_pk_bf16_f32 v246, v140, v141
    v_cvt_pk_bf16_f32 v247, v142, v143
    buffer_store_dwordx4 v[244:247], v10, s[32:35], 0 offen offset:1024 sc1
    s_waitcnt vmcnt(13)
    v_mfma_f32_16x16x32_bf16 v[224:227], a[128:131], a[96:99], 0
    v_mfma_f32_16x16x32_bf16 v[228:231], a[132:135], a[96:99], 0
    ds_read_b64_tr_b16 v[116:117], v30 offset:49152
    ds_read_b64_tr_b16 v[118:119], v30 offset:49664
    ds_read_b64_tr_b16 v[112:113], v31 offset:49152
    ds_read_b64_tr_b16 v[114:115], v31 offset:49664
    ds_read_b64_tr_b16 v[108:109], v32 offset:49152
    ds_read_b64_tr_b16 v[110:111], v32 offset:49664
    ds_read_b64_tr_b16 v[104:105], v33 offset:49152
    ds_read_b64_tr_b16 v[106:107], v33 offset:49664
    ds_read_b64_tr_b16 v[100:101], v30 offset:32768
    ds_read_b64_tr_b16 v[102:103], v30 offset:33280
    ds_read_b64_tr_b16 v[96:97], v31 offset:32768
    ds_read_b64_tr_b16 v[98:99], v31 offset:33280
    ds_read_b64_tr_b16 v[92:93], v32 offset:32768
    ds_read_b64_tr_b16 v[94:95], v32 offset:33280
    ds_read_b64_tr_b16 v[88:89], v33 offset:32768
    ds_read_b64_tr_b16 v[90:91], v33 offset:33280
    v_mfma_f32_16x16x32_bf16 v[232:235], a[136:139], a[96:99], 0
    v_mfma_f32_16x16x32_bf16 v[236:239], a[140:143], a[96:99], 0
    v_subrev_u32 v30, s92, v30
    v_subrev_u32 v31, s92, v31
    v_subrev_u32 v32, s92, v32
    v_subrev_u32 v33, s92, v33
    v_mfma_f32_16x16x32_bf16 v[208:211], a[128:131], a[100:103], 0
    v_mfma_f32_16x16x32_bf16 v[212:215], a[132:135], a[100:103], 0
    s_waitcnt lgkmcnt(0)
    s_barrier
    v_mfma_f32_16x16x32_bf16 v[216:219], a[136:139], a[100:103], 0
    v_mfma_f32_16x16x32_bf16 v[220:223], a[140:143], a[100:103], 0
    buffer_load_dwordx4 a[196:199], v41, s[32:35], s76 offen offset:2048 sc1
    s_waitcnt vmcnt(12)
    v_mfma_f32_16x16x32_bf16 v[192:195], a[128:131], a[104:107], 0
    v_mfma_f32_16x16x32_bf16 v[196:199], a[132:135], a[104:107], 0
    v_mfma_f32_16x16x32_bf16 v[200:203], a[136:139], a[104:107], 0
    v_mfma_f32_16x16x32_bf16 v[204:207], a[140:143], a[104:107], 0
    buffer_load_dwordx4 a[200:203], v42, s[32:35], s76 offen offset:2048 sc1
    v_mfma_f32_16x16x32_bf16 v[176:179], a[128:131], a[108:111], 0
    v_mfma_f32_16x16x32_bf16 v[180:183], a[132:135], a[108:111], 0
    v_mfma_f32_16x16x32_bf16 v[184:187], a[136:139], a[108:111], 0
    v_mfma_f32_16x16x32_bf16 v[188:191], a[140:143], a[108:111], 0
    buffer_load_dwordx4 a[204:207], v43, s[32:35], s76 offen offset:2048 sc1
    s_waitcnt vmcnt(12)
    v_mfma_f32_16x16x32_bf16 v[224:227], a[144:147], a[112:115], v[224:227]
    ds_read_b64_tr_b16 a[128:129], v30 offset:0
    v_mfma_f32_16x16x32_bf16 v[228:231], a[148:151], a[112:115], v[228:231]
    ds_read_b64_tr_b16 a[130:131], v30 offset:512
    v_mfma_f32_16x16x32_bf16 v[232:235], a[152:155], a[112:115], v[232:235]
    ds_read_b64_tr_b16 a[132:133], v31 offset:0
    v_mfma_f32_16x16x32_bf16 v[236:239], a[156:159], a[112:115], v[236:239]
    ds_read_b64_tr_b16 a[134:135], v31 offset:512
    s_mov_b32 s76, 8192
    buffer_load_dwordx4 a[208:211], v40, s[32:35], s76 offen offset:0 sc1
    v_mfma_f32_16x16x32_bf16 v[208:211], a[144:147], a[116:119], v[208:211]
    ds_read_b64_tr_b16 a[136:137], v32 offset:0
    v_mfma_f32_16x16x32_bf16 v[212:215], a[148:151], a[116:119], v[212:215]
    ds_read_b64_tr_b16 a[138:139], v32 offset:512
    v_mfma_f32_16x16x32_bf16 v[216:219], a[152:155], a[116:119], v[216:219]
    ds_read_b64_tr_b16 a[140:141], v33 offset:0
    v_mfma_f32_16x16x32_bf16 v[220:223], a[156:159], a[116:119], v[220:223]
    ds_read_b64_tr_b16 a[142:143], v33 offset:512
    buffer_load_dwordx4 a[212:215], v41, s[32:35], s76 offen offset:0 sc1
    s_waitcnt vmcnt(12)
    v_mfma_f32_16x16x32_bf16 v[192:195], a[144:147], a[120:123], v[192:195]
    ds_read_b64_tr_b16 a[96:97], v30 offset:16384
    v_mfma_f32_16x16x32_bf16 v[196:199], a[148:151], a[120:123], v[196:199]
    ds_read_b64_tr_b16 a[98:99], v30 offset:16896
    v_mfma_f32_16x16x32_bf16 v[200:203], a[152:155], a[120:123], v[200:203]
    ds_read_b64_tr_b16 a[100:101], v31 offset:16384
    v_mfma_f32_16x16x32_bf16 v[204:207], a[156:159], a[120:123], v[204:207]
    ds_read_b64_tr_b16 a[102:103], v31 offset:16896
    buffer_load_dwordx4 a[216:219], v42, s[32:35], s76 offen offset:0 sc1
    v_mfma_f32_16x16x32_bf16 v[176:179], a[144:147], a[124:127], v[176:179]
    ds_read_b64_tr_b16 a[104:105], v32 offset:16384
    v_mfma_f32_16x16x32_bf16 v[180:183], a[148:151], a[124:127], v[180:183]
    ds_read_b64_tr_b16 a[106:107], v32 offset:16896
    v_mfma_f32_16x16x32_bf16 v[184:187], a[152:155], a[124:127], v[184:187]
    ds_read_b64_tr_b16 a[108:109], v33 offset:16384
    v_mfma_f32_16x16x32_bf16 v[188:191], a[156:159], a[124:127], v[188:191]
    ds_read_b64_tr_b16 a[110:111], v33 offset:16896
    buffer_load_dwordx4 a[220:223], v43, s[32:35], s76 offen offset:0 sc1
    s_waitcnt vmcnt(12)
    v_mfma_f32_16x16x32_bf16 v[224:227], a[160:163], a[176:179], v[224:227]
    ds_read_b64_tr_b16 a[144:145], v30 offset:32768
    v_mfma_f32_16x16x32_bf16 v[228:231], a[164:167], a[176:179], v[228:231]
    ds_read_b64_tr_b16 a[146:147], v30 offset:33280
    v_mfma_f32_16x16x32_bf16 v[232:235], a[168:171], a[176:179], v[232:235]
    ds_read_b64_tr_b16 a[148:149], v31 offset:32768
    v_mfma_f32_16x16x32_bf16 v[236:239], a[172:175], a[176:179], v[236:239]
    ds_read_b64_tr_b16 a[150:151], v31 offset:33280
    buffer_load_dwordx4 a[224:227], v40, s[32:35], s76 offen offset:2048 sc1
    v_mfma_f32_16x16x32_bf16 v[208:211], a[160:163], a[180:183], v[208:211]
    ds_read_b64_tr_b16 a[152:153], v32 offset:32768
    v_mfma_f32_16x16x32_bf16 v[212:215], a[164:167], a[180:183], v[212:215]
    ds_read_b64_tr_b16 a[154:155], v32 offset:33280
    v_mfma_f32_16x16x32_bf16 v[216:219], a[168:171], a[180:183], v[216:219]
    ds_read_b64_tr_b16 a[156:157], v33 offset:32768
    v_mfma_f32_16x16x32_bf16 v[220:223], a[172:175], a[180:183], v[220:223]
    ds_read_b64_tr_b16 a[158:159], v33 offset:33280
    buffer_load_dwordx4 a[228:231], v41, s[32:35], s76 offen offset:2048 sc1
    s_waitcnt vmcnt(12)
    v_mfma_f32_16x16x32_bf16 v[192:195], a[160:163], a[184:187], v[192:195]
    ds_read_b64_tr_b16 a[112:113], v30 offset:49152
    v_mfma_f32_16x16x32_bf16 v[196:199], a[164:167], a[184:187], v[196:199]
    ds_read_b64_tr_b16 a[114:115], v30 offset:49664
    v_mfma_f32_16x16x32_bf16 v[200:203], a[168:171], a[184:187], v[200:203]
    ds_read_b64_tr_b16 a[116:117], v31 offset:49152
    v_mfma_f32_16x16x32_bf16 v[204:207], a[172:175], a[184:187], v[204:207]
    ds_read_b64_tr_b16 a[118:119], v31 offset:49664
    buffer_load_dwordx4 a[232:235], v42, s[32:35], s76 offen offset:2048 sc1
    v_mfma_f32_16x16x32_bf16 v[176:179], a[160:163], a[188:191], v[176:179]
    ds_read_b64_tr_b16 a[120:121], v32 offset:49152
    v_mfma_f32_16x16x32_bf16 v[180:183], a[164:167], a[188:191], v[180:183]
    ds_read_b64_tr_b16 a[122:123], v32 offset:49664
    v_mfma_f32_16x16x32_bf16 v[184:187], a[168:171], a[188:191], v[184:187]
    ds_read_b64_tr_b16 a[124:125], v33 offset:49152
    v_mfma_f32_16x16x32_bf16 v[188:191], a[172:175], a[188:191], v[188:191]
    ds_read_b64_tr_b16 a[126:127], v33 offset:49664
    s_waitcnt vmcnt(10)
    s_add_u32 s58, s51, 1024
    v_mov_b32 v9, s58
    s_mov_b64 exec, 1
    buffer_atomic_add v16, v9, s[32:35], 0 offen sc1
    s_mov_b64 exec, -1
    buffer_load_dwordx4 a[236:239], v43, s[32:35], s76 offen offset:2048 sc1
    s_waitcnt vmcnt(11)
    v_mfma_f32_16x16x32_bf16 v[224:227], a[0:3], a[192:195], v[224:227]
    ds_read_b64_tr_b16 a[160:161], v30 offset:4096
    v_mfma_f32_16x16x32_bf16 v[228:231], a[4:7], a[192:195], v[228:231]
    v_mov_b32 v8, v48
    v_mfma_f32_16x16x32_bf16 v[232:235], a[8:11], a[192:195], v[232:235]
    ds_read_b64_tr_b16 a[162:163], v30 offset:4608
    v_mfma_f32_16x16x32_bf16 v[236:239], a[12:15], a[192:195], v[236:239]
    ds_read_b64_tr_b16 a[164:165], v31 offset:4096
    s_mov_b32 s76, 12288
    buffer_load_dwordx4 a[240:243], v40, s[32:35], s76 offen offset:0 sc1
    v_mfma_f32_16x16x32_bf16 v[208:211], a[0:3], a[196:199], v[208:211]
    ds_read_b64_tr_b16 a[166:167], v31 offset:4608
    v_mfma_f32_16x16x32_bf16 v[212:215], a[4:7], a[196:199], v[212:215]
    ds_read_b64_tr_b16 a[168:169], v32 offset:4096
    v_mfma_f32_16x16x32_bf16 v[216:219], a[8:11], a[196:199], v[216:219]
    ds_read_b64_tr_b16 a[170:171], v32 offset:4608
    v_mfma_f32_16x16x32_bf16 v[220:223], a[12:15], a[196:199], v[220:223]
    ds_read_b64_tr_b16 a[172:173], v33 offset:4096
    buffer_load_dwordx4 a[244:247], v41, s[32:35], s76 offen offset:0 sc1
    s_waitcnt vmcnt(11)
    v_mfma_f32_16x16x32_bf16 v[192:195], a[0:3], a[200:203], v[192:195]
    ds_read_b64_tr_b16 a[174:175], v33 offset:4608
    v_mfma_f32_16x16x32_bf16 v[196:199], a[4:7], a[200:203], v[196:199]
    ds_read_b64_tr_b16 a[176:177], v30 offset:20480
    v_mfma_f32_16x16x32_bf16 v[200:203], a[8:11], a[200:203], v[200:203]
    ds_read_b64_tr_b16 a[178:179], v30 offset:20992
    v_mfma_f32_16x16x32_bf16 v[204:207], a[12:15], a[200:203], v[204:207]
    ds_read_b64_tr_b16 a[180:181], v31 offset:20480
    buffer_load_dwordx4 a[248:251], v42, s[32:35], s76 offen offset:0 sc1
    v_mfma_f32_16x16x32_bf16 v[176:179], a[0:3], a[204:207], v[176:179]
    ds_read_b64_tr_b16 a[182:183], v31 offset:20992
    v_mfma_f32_16x16x32_bf16 v[180:183], a[4:7], a[204:207], v[180:183]
    ds_read_b64_tr_b16 a[184:185], v32 offset:20480
    v_mfma_f32_16x16x32_bf16 v[184:187], a[8:11], a[204:207], v[184:187]
    ds_read_b64_tr_b16 a[186:187], v32 offset:20992
    v_mfma_f32_16x16x32_bf16 v[188:191], a[12:15], a[204:207], v[188:191]
    ds_read_b64_tr_b16 a[188:189], v33 offset:20480
    buffer_load_dwordx4 a[252:255], v43, s[32:35], s76 offen offset:0 sc1
    s_waitcnt vmcnt(11)
    v_mfma_f32_16x16x32_bf16 v[224:227], a[16:19], a[208:211], v[224:227]
    ds_read_b64_tr_b16 a[190:191], v33 offset:20992
    v_mfma_f32_16x16x32_bf16 v[228:231], a[20:23], a[208:211], v[228:231]
    ds_read_b64_tr_b16 a[0:1], v30 offset:36864
    v_mfma_f32_16x16x32_bf16 v[232:235], a[24:27], a[208:211], v[232:235]
    ds_read_b64_tr_b16 a[2:3], v30 offset:37376
    v_mfma_f32_16x16x32_bf16 v[236:239], a[28:31], a[208:211], v[236:239]
    ds_read_b64_tr_b16 a[4:5], v31 offset:36864
    buffer_load_dwordx4 v[252:255], v40, s[32:35], s76 offen offset:2048 sc1
    v_mfma_f32_16x16x32_bf16 v[208:211], a[16:19], a[212:215], v[208:211]
    ds_read_b64_tr_b16 a[6:7], v31 offset:37376
    v_mfma_f32_16x16x32_bf16 v[212:215], a[20:23], a[212:215], v[212:215]
    ds_read_b64_tr_b16 a[8:9], v32 offset:36864
    v_mfma_f32_16x16x32_bf16 v[216:219], a[24:27], a[212:215], v[216:219]
    ds_read_b64_tr_b16 a[10:11], v32 offset:37376
    v_mfma_f32_16x16x32_bf16 v[220:223], a[28:31], a[212:215], v[220:223]
    ds_read_b64_tr_b16 a[12:13], v33 offset:36864
    buffer_load_dwordx4 v[248:251], v41, s[32:35], s76 offen offset:2048 sc1
    s_waitcnt vmcnt(11)
    v_mfma_f32_16x16x32_bf16 v[192:195], a[16:19], a[216:219], v[192:195]
    ds_read_b64_tr_b16 a[14:15], v33 offset:37376
    v_mfma_f32_16x16x32_bf16 v[196:199], a[20:23], a[216:219], v[196:199]
    ds_read_b64_tr_b16 a[192:193], v30 offset:53248
    v_mfma_f32_16x16x32_bf16 v[200:203], a[24:27], a[216:219], v[200:203]
    ds_read_b64_tr_b16 a[194:195], v30 offset:53760
    v_mfma_f32_16x16x32_bf16 v[204:207], a[28:31], a[216:219], v[204:207]
    ds_read_b64_tr_b16 a[196:197], v31 offset:53248
    buffer_load_dwordx4 v[172:175], v42, s[32:35], s76 offen offset:2048 sc1
    v_mfma_f32_16x16x32_bf16 v[176:179], a[16:19], a[220:223], v[176:179]
    ds_read_b64_tr_b16 a[198:199], v31 offset:53760
    v_mfma_f32_16x16x32_bf16 v[180:183], a[20:23], a[220:223], v[180:183]
    ds_read_b64_tr_b16 a[200:201], v32 offset:53248
    v_mfma_f32_16x16x32_bf16 v[184:187], a[24:27], a[220:223], v[184:187]
    ds_read_b64_tr_b16 a[202:203], v32 offset:53760
    v_mfma_f32_16x16x32_bf16 v[188:191], a[28:31], a[220:223], v[188:191]
    ds_read_b64_tr_b16 a[204:205], v33 offset:53248
    buffer_load_dwordx4 v[168:171], v43, s[32:35], s76 offen offset:2048 sc1
    s_waitcnt vmcnt(11)
    v_mfma_f32_16x16x32_bf16 v[224:227], a[32:35], a[224:227], v[224:227]
    ds_read_b64_tr_b16 a[206:207], v33 offset:53760
    v_mfma_f32_16x16x32_bf16 v[228:231], a[36:39], a[224:227], v[228:231]
    ds_read_b64_tr_b16 a[16:17], v30 offset:8192
    v_mfma_f32_16x16x32_bf16 v[232:235], a[40:43], a[224:227], v[232:235]
    ds_read_b64_tr_b16 a[18:19], v30 offset:8704
    v_mfma_f32_16x16x32_bf16 v[236:239], a[44:47], a[224:227], v[236:239]
    ds_read_b64_tr_b16 a[20:21], v31 offset:8192
    s_mov_b32 s76, 16384
    buffer_load_dwordx4 v[164:167], v40, s[32:35], s76 offen offset:0 sc1
    v_mfma_f32_16x16x32_bf16 v[208:211], a[32:35], a[228:231], v[208:211]
    ds_read_b64_tr_b16 a[22:23], v31 offset:8704
    v_mfma_f32_16x16x32_bf16 v[212:215], a[36:39], a[228:231], v[212:215]
    ds_read_b64_tr_b16 a[24:25], v32 offset:8192
    v_mfma_f32_16x16x32_bf16 v[216:219], a[40:43], a[228:231], v[216:219]
    ds_read_b64_tr_b16 a[26:27], v32 offset:8704
    v_mfma_f32_16x16x32_bf16 v[220:223], a[44:47], a[228:231], v[220:223]
    ds_read_b64_tr_b16 a[28:29], v33 offset:8192
    buffer_load_dwordx4 v[160:163], v41, s[32:35], s76 offen offset:0 sc1
    s_waitcnt vmcnt(10)
    v_mfma_f32_16x16x32_bf16 v[192:195], a[32:35], a[232:235], v[192:195]
    ds_read_b64_tr_b16 a[30:31], v33 offset:8704
    v_mfma_f32_16x16x32_bf16 v[196:199], a[36:39], a[232:235], v[196:199]
    ds_read_b64_tr_b16 a[208:209], v30 offset:24576
    v_mfma_f32_16x16x32_bf16 v[200:203], a[40:43], a[232:235], v[200:203]
    ds_read_b64_tr_b16 a[210:211], v30 offset:25088
    v_mfma_f32_16x16x32_bf16 v[204:207], a[44:47], a[232:235], v[204:207]
    ds_read_b64_tr_b16 a[212:213], v31 offset:24576
    buffer_load_dwordx4 v[156:159], v42, s[32:35], s76 offen offset:0 sc1
    v_mfma_f32_16x16x32_bf16 v[176:179], a[32:35], a[236:239], v[176:179]
    ds_read_b64_tr_b16 a[214:215], v31 offset:25088
    v_mfma_f32_16x16x32_bf16 v[180:183], a[36:39], a[236:239], v[180:183]
    ds_read_b64_tr_b16 a[216:217], v32 offset:24576
    v_mfma_f32_16x16x32_bf16 v[184:187], a[40:43], a[236:239], v[184:187]
    ds_read_b64_tr_b16 a[218:219], v32 offset:25088
    v_mfma_f32_16x16x32_bf16 v[188:191], a[44:47], a[236:239], v[188:191]
    ds_read_b64_tr_b16 a[220:221], v33 offset:24576
    buffer_load_dwordx4 v[152:155], v43, s[32:35], s76 offen offset:0 sc1
    s_waitcnt vmcnt(10)
    v_mfma_f32_16x16x32_bf16 v[224:227], a[48:51], a[240:243], v[224:227]
    ds_read_b64_tr_b16 a[222:223], v33 offset:25088
    v_mfma_f32_16x16x32_bf16 v[228:231], a[52:55], a[240:243], v[228:231]
    ds_read_b64_tr_b16 a[32:33], v30 offset:40960
    v_mfma_f32_16x16x32_bf16 v[232:235], a[56:59], a[240:243], v[232:235]
    ds_read_b64_tr_b16 a[34:35], v30 offset:41472
    v_mfma_f32_16x16x32_bf16 v[236:239], a[60:63], a[240:243], v[236:239]
    ds_read_b64_tr_b16 a[36:37], v31 offset:40960
    buffer_load_dwordx4 v[148:151], v40, s[32:35], s76 offen offset:2048 sc1
    v_mfma_f32_16x16x32_bf16 v[208:211], a[48:51], a[244:247], v[208:211]
    ds_read_b64_tr_b16 a[38:39], v31 offset:41472
    v_mfma_f32_16x16x32_bf16 v[212:215], a[52:55], a[244:247], v[212:215]
    ds_read_b64_tr_b16 a[40:41], v32 offset:40960
    v_mfma_f32_16x16x32_bf16 v[216:219], a[56:59], a[244:247], v[216:219]
    ds_read_b64_tr_b16 a[42:43], v32 offset:41472
    v_mfma_f32_16x16x32_bf16 v[220:223], a[60:63], a[244:247], v[220:223]
    ds_read_b64_tr_b16 a[44:45], v33 offset:40960
    buffer_load_dwordx4 v[144:147], v41, s[32:35], s76 offen offset:2048 sc1
    s_waitcnt vmcnt(10)
    v_mfma_f32_16x16x32_bf16 v[192:195], a[48:51], a[248:251], v[192:195]
    ds_read_b64_tr_b16 a[46:47], v33 offset:41472
    v_mfma_f32_16x16x32_bf16 v[196:199], a[52:55], a[248:251], v[196:199]
    ds_read_b64_tr_b16 a[224:225], v30 offset:57344
    v_mfma_f32_16x16x32_bf16 v[200:203], a[56:59], a[248:251], v[200:203]
    ds_read_b64_tr_b16 a[226:227], v30 offset:57856
    v_mfma_f32_16x16x32_bf16 v[204:207], a[60:63], a[248:251], v[204:207]
    ds_read_b64_tr_b16 a[228:229], v31 offset:57344
    buffer_load_dwordx4 v[140:143], v42, s[32:35], s76 offen offset:2048 sc1
    v_mfma_f32_16x16x32_bf16 v[176:179], a[48:51], a[252:255], v[176:179]
    ds_read_b64_tr_b16 a[230:231], v31 offset:57856
    v_mfma_f32_16x16x32_bf16 v[180:183], a[52:55], a[252:255], v[180:183]
    ds_read_b64_tr_b16 a[232:233], v32 offset:57344
    v_mfma_f32_16x16x32_bf16 v[184:187], a[56:59], a[252:255], v[184:187]
    ds_read_b64_tr_b16 a[234:235], v32 offset:57856
    v_mfma_f32_16x16x32_bf16 v[188:191], a[60:63], a[252:255], v[188:191]
    ds_read_b64_tr_b16 a[236:237], v33 offset:57344
    buffer_load_dwordx4 v[136:139], v43, s[32:35], s76 offen offset:2048 sc1
    s_waitcnt vmcnt(10)
    v_mfma_f32_16x16x32_bf16 v[224:227], a[64:67], v[252:255], v[224:227]
    ds_read_b64_tr_b16 a[238:239], v33 offset:57856
    v_mfma_f32_16x16x32_bf16 v[228:231], a[68:71], v[252:255], v[228:231]
    ds_read_b64_tr_b16 a[48:49], v30 offset:12288
    v_mfma_f32_16x16x32_bf16 v[232:235], a[72:75], v[252:255], v[232:235]
    ds_read_b64_tr_b16 a[50:51], v30 offset:12800
    v_mfma_f32_16x16x32_bf16 v[236:239], a[76:79], v[252:255], v[236:239]
    ds_read_b64_tr_b16 a[52:53], v31 offset:12288
    buffer_load_dword v9, v8, s[32:35], 0 offen sc1
    s_mov_b32 s76, 20480
    s_cmp_eq_u32 s70, 3
    s_cselect_b32 s58, 2147483648, 0
    v_or_b32 v40, s58, v40
    buffer_load_dwordx4 v[132:135], v40, s[32:35], s76 offen offset:0 sc1
    v_mfma_f32_16x16x32_bf16 v[208:211], a[64:67], v[248:251], v[208:211]
    ds_read_b64_tr_b16 a[54:55], v31 offset:12800
    v_mfma_f32_16x16x32_bf16 v[212:215], a[68:71], v[248:251], v[212:215]
    ds_read_b64_tr_b16 a[56:57], v32 offset:12288
    v_mfma_f32_16x16x32_bf16 v[216:219], a[72:75], v[248:251], v[216:219]
    ds_read_b64_tr_b16 a[58:59], v32 offset:12800
    v_mfma_f32_16x16x32_bf16 v[220:223], a[76:79], v[248:251], v[220:223]
    ds_read_b64_tr_b16 a[60:61], v33 offset:12288
    v_or_b32 v41, s58, v41
    buffer_load_dwordx4 v[128:131], v41, s[32:35], s76 offen offset:0 sc1
    s_waitcnt vmcnt(11)
    v_mfma_f32_16x16x32_bf16 v[192:195], a[64:67], v[172:175], v[192:195]
    ds_read_b64_tr_b16 a[62:63], v33 offset:12800
    v_mfma_f32_16x16x32_bf16 v[196:199], a[68:71], v[172:175], v[196:199]
    ds_read_b64_tr_b16 a[240:241], v30 offset:28672
    v_mfma_f32_16x16x32_bf16 v[200:203], a[72:75], v[172:175], v[200:203]
    ds_read_b64_tr_b16 a[242:243], v30 offset:29184
    v_mfma_f32_16x16x32_bf16 v[204:207], a[76:79], v[172:175], v[204:207]
    ds_read_b64_tr_b16 a[244:245], v31 offset:28672
    v_or_b32 v42, s58, v42
    buffer_load_dwordx4 v[124:127], v42, s[32:35], s76 offen offset:0 sc1
    v_mfma_f32_16x16x32_bf16 v[176:179], a[64:67], v[168:171], v[176:179]
    ds_read_b64_tr_b16 a[246:247], v31 offset:29184
    v_mfma_f32_16x16x32_bf16 v[180:183], a[68:71], v[168:171], v[180:183]
    ds_read_b64_tr_b16 a[248:249], v32 offset:28672
    v_mfma_f32_16x16x32_bf16 v[184:187], a[72:75], v[168:171], v[184:187]
    ds_read_b64_tr_b16 a[250:251], v32 offset:29184
    v_mfma_f32_16x16x32_bf16 v[188:191], a[76:79], v[168:171], v[188:191]
    ds_read_b64_tr_b16 a[252:253], v33 offset:28672
    v_or_b32 v43, s58, v43
    buffer_load_dwordx4 v[120:123], v43, s[32:35], s76 offen offset:0 sc1
    s_waitcnt vmcnt(11)
    v_mfma_f32_16x16x32_bf16 v[224:227], a[80:83], v[164:167], v[224:227]
    ds_read_b64_tr_b16 a[254:255], v33 offset:29184
    v_mfma_f32_16x16x32_bf16 v[228:231], a[84:87], v[164:167], v[228:231]
    ds_read_b64_tr_b16 a[64:65], v30 offset:45056
    v_mfma_f32_16x16x32_bf16 v[232:235], a[88:91], v[164:167], v[232:235]
    ds_read_b64_tr_b16 a[66:67], v30 offset:45568
    v_mfma_f32_16x16x32_bf16 v[236:239], a[92:95], v[164:167], v[236:239]
    ds_read_b64_tr_b16 a[68:69], v31 offset:45056
    v_mfma_f32_16x16x32_bf16 v[208:211], a[80:83], v[160:163], v[208:211]
    ds_read_b64_tr_b16 a[70:71], v31 offset:45568
    v_mfma_f32_16x16x32_bf16 v[212:215], a[84:87], v[160:163], v[212:215]
    ds_read_b64_tr_b16 a[72:73], v32 offset:45056
    v_mfma_f32_16x16x32_bf16 v[216:219], a[88:91], v[160:163], v[216:219]
    ds_read_b64_tr_b16 a[74:75], v32 offset:45568
    v_mfma_f32_16x16x32_bf16 v[220:223], a[92:95], v[160:163], v[220:223]
    ds_read_b64_tr_b16 a[76:77], v33 offset:45056
L_pad_4:
    s_cbranch_execz L_warm_back
    s_waitcnt vmcnt(9)
    v_mfma_f32_16x16x32_bf16 v[192:195], a[80:83], v[156:159], v[192:195]
    ds_read_b64_tr_b16 a[78:79], v33 offset:45568
    v_mfma_f32_16x16x32_bf16 v[196:199], a[84:87], v[156:159], v[196:199]
    v_mfma_f32_16x16x32_bf16 v[200:203], a[88:91], v[156:159], v[200:203]
    v_mfma_f32_16x16x32_bf16 v[204:207], a[92:95], v[156:159], v[204:207]
    v_mfma_f32_16x16x32_bf16 v[176:179], a[80:83], v[152:155], v[176:179]
    v_mfma_f32_16x16x32_bf16 v[180:183], a[84:87], v[152:155], v[180:183]
    v_mfma_f32_16x16x32_bf16 v[184:187], a[88:91], v[152:155], v[184:187]
    v_mfma_f32_16x16x32_bf16 v[188:191], a[92:95], v[152:155], v[188:191]
    s_waitcnt vmcnt(7)
    v_mfma_f32_16x16x32_bf16 v[224:227], v[116:119], v[148:151], v[224:227]
    ds_read_b64_tr_b16 a[80:81], v30 offset:61440
    v_mfma_f32_16x16x32_bf16 v[228:231], v[112:115], v[148:151], v[228:231]
    ds_read_b64_tr_b16 a[82:83], v30 offset:61952
    v_mfma_f32_16x16x32_bf16 v[232:235], v[108:111], v[148:151], v[232:235]
    ds_read_b64_tr_b16 a[84:85], v31 offset:61440
    v_mfma_f32_16x16x32_bf16 v[236:239], v[104:107], v[148:151], v[236:239]
    ds_read_b64_tr_b16 a[86:87], v31 offset:61952
    v_mfma_f32_16x16x32_bf16 v[208:211], v[116:119], v[144:147], v[208:211]
    ds_read_b64_tr_b16 a[88:89], v32 offset:61440
    v_mfma_f32_16x16x32_bf16 v[212:215], v[112:115], v[144:147], v[212:215]
    ds_read_b64_tr_b16 a[90:91], v32 offset:61952
    v_mfma_f32_16x16x32_bf16 v[216:219], v[108:111], v[144:147], v[216:219]
    ds_read_b64_tr_b16 a[92:93], v33 offset:61440
    v_mfma_f32_16x16x32_bf16 v[220:223], v[104:107], v[144:147], v[220:223]
    ds_read_b64_tr_b16 a[94:95], v33 offset:61952
    s_waitcnt vmcnt(5)
    v_mfma_f32_16x16x32_bf16 v[192:195], v[116:119], v[140:143], v[192:195]
    v_mfma_f32_16x16x32_bf16 v[196:199], v[112:115], v[140:143], v[196:199]
    v_mfma_f32_16x16x32_bf16 v[200:203], v[108:111], v[140:143], v[200:203]
    v_mfma_f32_16x16x32_bf16 v[204:207], v[104:107], v[140:143], v[204:207]
    v_mfma_f32_16x16x32_bf16 v[176:179], v[116:119], v[136:139], v[176:179]
    v_mfma_f32_16x16x32_bf16 v[180:183], v[112:115], v[136:139], v[180:183]
    v_mfma_f32_16x16x32_bf16 v[184:187], v[108:111], v[136:139], v[184:187]
    v_mfma_f32_16x16x32_bf16 v[188:191], v[104:107], v[136:139], v[188:191]
    s_waitcnt vmcnt(2)
    v_mfma_f32_16x16x32_bf16 v[224:227], v[100:103], v[132:135], v[224:227]
    v_mfma_f32_16x16x32_bf16 v[228:231], v[96:99], v[132:135], v[228:231]
    v_mfma_f32_16x16x32_bf16 v[232:235], v[92:95], v[132:135], v[232:235]
    v_mfma_f32_16x16x32_bf16 v[236:239], v[88:91], v[132:135], v[236:239]
    v_cmp_ne_u32 vcc, 8, v9
    s_mov_b32 s93, 0
    s_cbranch_vccz L_o_ok
L_o_retry:
    buffer_load_dword v9, v8, s[32:35], 0 offen sc1
    s_add_u32 s93, s93, 1
    s_cmp_ge_u32 s93, 0x40000
    s_waitcnt vmcnt(0)
    v_cmp_ne_u32 vcc, 8, v9
    s_cbranch_scc1 L_o_ok
    s_cbranch_vccnz L_o_retry
L_o_ok:
    v_mfma_f32_16x16x32_bf16 v[208:211], v[100:103], v[128:131], v[208:211]
    v_mfma_f32_16x16x32_bf16 v[212:215], v[96:99], v[128:131], v[212:215]
    v_mfma_f32_16x16x32_bf16 v[216:219], v[92:95], v[128:131], v[216:219]
    v_mfma_f32_16x16x32_bf16 v[220:223], v[88:91], v[128:131], v[220:223]
    s_mov_b32 s79, 0
    buffer_load_dwordx4 v[244:247], v25, s[32:35], s79 offen offset:0 sc1
    s_waitcnt vmcnt(1)
    v_mfma_f32_16x16x32_bf16 v[192:195], v[100:103], v[124:127], v[192:195]
    v_mfma_f32_16x16x32_bf16 v[196:199], v[96:99], v[124:127], v[196:199]
    v_mfma_f32_16x16x32_bf16 v[200:203], v[92:95], v[124:127], v[200:203]
    v_mfma_f32_16x16x32_bf16 v[204:207], v[88:91], v[124:127], v[204:207]
    buffer_load_dwordx4 v[240:243], v25, s[32:35], s79 offen offset:2048 sc1
    v_mfma_f32_16x16x32_bf16 v[176:179], v[100:103], v[120:123], v[176:179]
    v_mfma_f32_16x16x32_bf16 v[180:183], v[96:99], v[120:123], v[180:183]
    v_mfma_f32_16x16x32_bf16 v[184:187], v[92:95], v[120:123], v[184:187]
    v_mfma_f32_16x16x32_bf16 v[188:191], v[88:91], v[120:123], v[188:191]
    s_mov_b32 s79, 4096
    buffer_load_dwordx4 v[84:87], v25, s[32:35], s79 offen offset:0 sc1
    buffer_load_dwordx4 v[80:83], v25, s[32:35], s79 offen offset:2048 sc1
    s_mov_b32 s79, 8192
    buffer_load_dwordx4 v[76:79], v25, s[32:35], s79 offen offset:0 sc1
    buffer_load_dwordx4 v[72:75], v25, s[32:35], s79 offen offset:2048 sc1
    s_mov_b32 s79, 12288
    buffer_load_dwordx4 v[68:71], v25, s[32:35], s79 offen offset:0 sc1
    buffer_load_dwordx4 v[64:67], v25, s[32:35], s79 offen offset:2048 sc1
    s_mov_b32 s79, 16384
    buffer_load_dwordx4 v[60:63], v25, s[32:35], s79 offen offset:0 sc1
    s_waitcnt vmcnt(8) lgkmcnt(15)
    v_mfma_f32_16x16x32_bf16 v[224:227], a[128:131], v[244:247], v[224:227]
    ds_write_b128 v44, v[208:211] offset:0
    v_mfma_f32_16x16x32_bf16 v[228:231], a[132:135], v[244:247], v[228:231]
    v_mfma_f32_16x16x32_bf16 v[232:235], a[136:139], v[244:247], v[232:235]
    ds_write_b128 v44, v[212:215] offset:1024
    v_mfma_f32_16x16x32_bf16 v[236:239], a[140:143], v[244:247], v[236:239]
    buffer_load_dwordx4 v[56:59], v25, s[32:35], s79 offen offset:2048 sc1
    s_waitcnt vmcnt(8)
    v_mfma_f32_16x16x32_bf16 v[224:227], a[96:99], v[240:243], v[224:227]
    ds_write_b128 v44, v[216:219] offset:2048
    v_mfma_f32_16x16x32_bf16 v[228:231], a[100:103], v[240:243], v[228:231]
    v_mfma_f32_16x16x32_bf16 v[232:235], a[104:107], v[240:243], v[232:235]
    ds_write_b128 v44, v[220:223] offset:3072
    v_mfma_f32_16x16x32_bf16 v[236:239], a[108:111], v[240:243], v[236:239]
    s_mov_b32 s79, 20480
    buffer_load_dwordx4 v[52:55], v25, s[32:35], s79 offen offset:0 sc1
    s_waitcnt vmcnt(8)
    v_mfma_f32_16x16x32_bf16 v[224:227], a[144:147], v[84:87], v[224:227]
    ds_write_b128 v45, v[192:195] offset:0
    v_mfma_f32_16x16x32_bf16 v[228:231], a[148:151], v[84:87], v[228:231]
    v_mfma_f32_16x16x32_bf16 v[232:235], a[152:155], v[84:87], v[232:235]
    ds_write_b128 v45, v[196:199] offset:1024
    v_mfma_f32_16x16x32_bf16 v[236:239], a[156:159], v[84:87], v[236:239]
    buffer_load_dwordx4 v[12:15], v25, s[32:35], s79 offen offset:2048 sc1
    s_waitcnt vmcnt(8)
    v_mfma_f32_16x16x32_bf16 v[224:227], a[112:115], v[80:83], v[224:227]
    ds_write_b128 v45, v[200:203] offset:2048
    v_mfma_f32_16x16x32_bf16 v[228:231], a[116:119], v[80:83], v[228:231]
    v_mfma_f32_16x16x32_bf16 v[232:235], a[120:123], v[80:83], v[232:235]
    ds_write_b128 v45, v[204:207] offset:3072
    v_mfma_f32_16x16x32_bf16 v[236:239], a[124:127], v[80:83], v[236:239]
    s_mov_b32 s79, 24576
    buffer_load_dwordx4 v[252:255], v25, s[32:35], s79 offen offset:0 sc1
    s_waitcnt vmcnt(8)
    v_mfma_f32_16x16x32_bf16 v[224:227], a[160:163], v[76:79], v[224:227]
    ds_write_b128 v46, v[176:179] offset:0
    v_mfma_f32_16x16x32_bf16 v[228:231], a[164:167], v[76:79], v[228:231]
    v_mfma_f32_16x16x32_bf16 v[232:235], a[168:171], v[76:79], v[232:235]
    ds_write_b128 v46, v[180:183] offset:1024
    v_mfma_f32_16x16x32_bf16 v[236:239], a[172:175], v[76:79], v[236:239]
    buffer_load_dwordx4 v[248:251], v25, s[32:35], s79 offen offset:2048 sc1
    s_waitcnt vmcnt(8)
    v_mfma_f32_16x16x32_bf16 v[224:227], a[176:179], v[72:75], v[224:227]
    ds_write_b128 v46, v[184:187] offset:2048
    v_mfma_f32_16x16x32_bf16 v[228:231], a[180:183], v[72:75], v[228:231]
    v_mfma_f32_16x16x32_bf16 v[232:235], a[184:187], v[72:75], v[232:235]
    ds_write_b128 v46, v[188:191] offset:3072
    v_mfma_f32_16x16x32_bf16 v[236:239], a[188:191], v[72:75], v[236:239]
    s_mov_b32 s79, 28672
    buffer_load_dwordx4 v[172:175], v25, s[32:35], s79 offen offset:0 sc1
    buffer_load_dwordx4 v[168:171], v25, s[32:35], s79 offen offset:2048 sc1
    s_waitcnt lgkmcnt(0)
    s_barrier
    s_waitcnt vmcnt(9)
    v_mfma_f32_16x16x32_bf16 v[224:227], a[0:3], v[68:71], v[224:227]
    ds_read_b128 v[208:211], v39 offset:0
    v_mfma_f32_16x16x32_bf16 v[228:231], a[4:7], v[68:71], v[228:231]
    ds_read_b128 v[212:215], v39 offset:1024
    v_mfma_f32_16x16x32_bf16 v[232:235], a[8:11], v[68:71], v[232:235]
    ds_read_b128 v[216:219], v39 offset:2048
    v_mfma_f32_16x16x32_bf16 v[236:239], a[12:15], v[68:71], v[236:239]
    ds_read_b128 v[220:223], v39 offset:3072
    s_waitcnt vmcnt(8)
    v_mfma_f32_16x16x32_bf16 v[224:227], a[192:195], v[64:67], v[224:227]
    ds_read_b128 v[192:195], v39 offset:4096
    v_mfma_f32_16x16x32_bf16 v[228:231], a[196:199], v[64:67], v[228:231]
    ds_read_b128 v[196:199], v39 offset:5120
    v_mfma_f32_16x16x32_bf16 v[232:235], a[200:203], v[64:67], v[232:235]
    ds_read_b128 v[200:203], v39 offset:6144
    v_mfma_f32_16x16x32_bf16 v[236:239], a[204:207], v[64:67], v[236:239]
    ds_read_b128 v[204:207], v39 offset:7168
    s_waitcnt vmcnt(7)
    v_mfma_f32_16x16x32_bf16 v[224:227], a[16:19], v[60:63], v[224:227]
    ds_read_b128 v[176:179], v39 offset:8192
    v_mfma_f32_16x16x32_bf16 v[228:231], a[20:23], v[60:63], v[228:231]
    ds_read_b128 v[180:183], v39 offset:9216
    v_mfma_f32_16x16x32_bf16 v[232:235], a[24:27], v[60:63], v[232:235]
    ds_read_b128 v[184:187], v39 offset:10240
    v_mfma_f32_16x16x32_bf16 v[236:239], a[28:31], v[60:63], v[236:239]
    ds_read_b128 v[188:191], v39 offset:11264
    s_waitcnt vmcnt(6)
    v_mfma_f32_16x16x32_bf16 v[224:227], a[208:211], v[56:59], v[224:227]
    s_waitcnt lgkmcnt(7)
    v_add_f32 v208, v208, v192
    v_mfma_f32_16x16x32_bf16 v[228:231], a[212:215], v[56:59], v[228:231]
    v_add_f32 v209, v209, v193
    v_mfma_f32_16x16x32_bf16 v[232:235], a[216:219], v[56:59], v[232:235]
    v_add_f32 v210, v210, v194
    v_mfma_f32_16x16x32_bf16 v[236:239], a[220:223], v[56:59], v[236:239]
    v_add_f32 v211, v211, v195
    s_waitcnt vmcnt(5)
    v_mfma_f32_16x16x32_bf16 v[224:227], a[32:35], v[52:55], v[224:227]
    s_waitcnt lgkmcnt(6)
    v_add_f32 v212, v212, v196
    v_mfma_f32_16x16x32_bf16 v[228:231], a[36:39], v[52:55], v[228:231]
    v_add_f32 v213, v213, v197
    v_mfma_f32_16x16x32_bf16 v[232:235], a[40:43], v[52:55], v[232:235]
    v_add_f32 v214, v214, v198
    v_mfma_f32_16x16x32_bf16 v[236:239], a[44:47], v[52:55], v[236:239]
    v_add_f32 v215, v215, v199
    s_waitcnt vmcnt(4)
    v_mfma_f32_16x16x32_bf16 v[224:227], a[224:227], v[12:15], v[224:227]
    s_waitcnt lgkmcnt(5)
    v_add_f32 v216, v216, v200
    v_mfma_f32_16x16x32_bf16 v[228:231], a[228:231], v[12:15], v[228:231]
    v_add_f32 v217, v217, v201
    v_mfma_f32_16x16x32_bf16 v[232:235], a[232:235], v[12:15], v[232:235]
    v_add_f32 v218, v218, v202
    v_mfma_f32_16x16x32_bf16 v[236:239], a[236:239], v[12:15], v[236:239]
    v_add_f32 v219, v219, v203
    s_waitcnt vmcnt(3)
    v_mfma_f32_16x16x32_bf16 v[224:227], a[48:51], v[252:255], v[224:227]
    s_waitcnt lgkmcnt(4)
    v_add_f32 v220, v220, v204
    v_mfma_f32_16x16x32_bf16 v[228:231], a[52:55], v[252:255], v[228:231]
    v_add_f32 v221, v221, v205
    v_mfma_f32_16x16x32_bf16 v[232:235], a[56:59], v[252:255], v[232:235]
    v_add_f32 v222, v222, v206
    v_mfma_f32_16x16x32_bf16 v[236:239], a[60:63], v[252:255], v[236:239]
    v_add_f32 v223, v223, v207
    s_waitcnt vmcnt(2)
    v_mfma_f32_16x16x32_bf16 v[224:227], a[240:243], v[248:251], v[224:227]
    s_waitcnt lgkmcnt(3)
    v_add_f32 v208, v208, v176
    v_mfma_f32_16x16x32_bf16 v[228:231], a[244:247], v[248:251], v[228:231]
    v_add_f32 v209, v209, v177
    v_mfma_f32_16x16x32_bf16 v[232:235], a[248:251], v[248:251], v[232:235]
    v_add_f32 v210, v210, v178
    v_mfma_f32_16x16x32_bf16 v[236:239], a[252:255], v[248:251], v[236:239]
    v_add_f32 v211, v211, v179
    s_waitcnt vmcnt(1)
    v_mfma_f32_16x16x32_bf16 v[224:227], a[64:67], v[172:175], v[224:227]
    s_waitcnt lgkmcnt(2)
    v_add_f32 v212, v212, v180
    v_mfma_f32_16x16x32_bf16 v[228:231], a[68:71], v[172:175], v[228:231]
    v_add_f32 v213, v213, v181
    v_mfma_f32_16x16x32_bf16 v[232:235], a[72:75], v[172:175], v[232:235]
    v_add_f32 v214, v214, v182
    v_mfma_f32_16x16x32_bf16 v[236:239], a[76:79], v[172:175], v[236:239]
    v_add_f32 v215, v215, v183
    s_waitcnt vmcnt(0)
    v_mfma_f32_16x16x32_bf16 v[224:227], a[80:83], v[168:171], v[224:227]
    s_waitcnt lgkmcnt(1)
    v_add_f32 v216, v216, v184
    v_mfma_f32_16x16x32_bf16 v[228:231], a[84:87], v[168:171], v[228:231]
    v_add_f32 v217, v217, v185
    v_mfma_f32_16x16x32_bf16 v[232:235], a[88:91], v[168:171], v[232:235]
    v_add_f32 v218, v218, v186
    v_mfma_f32_16x16x32_bf16 v[236:239], a[92:95], v[168:171], v[236:239]
    v_add_f32 v219, v219, v187
    s_waitcnt lgkmcnt(0)
    v_add_f32 v220, v220, v188
    v_add_f32 v221, v221, v189
    v_add_f32 v222, v222, v190
    v_add_f32 v223, v223, v191
    s_mov_b32 s79, 8192
    v_pk_add_f32 v[224:225], v[224:225], v[208:209]
    v_pk_add_f32 v[226:227], v[226:227], v[210:211]
    v_pk_add_f32 v[228:229], v[228:229], v[212:213]
    v_pk_add_f32 v[230:231], v[230:231], v[214:215]
    v_pk_add_f32 v[232:233], v[232:233], v[216:217]
    v_pk_add_f32 v[234:235], v[234:235], v[218:219]
    v_pk_add_f32 v[236:237], v[236:237], v[220:221]
    v_pk_add_f32 v[238:239], v[238:239], v[222:223]
    v_cvt_pk_bf16_f32 v192, v224, v225
    v_cvt_pk_bf16_f32 v193, v226, v227
    v_cvt_pk_bf16_f32 v194, v228, v229
    v_cvt_pk_bf16_f32 v195, v230, v231
    v_cvt_pk_bf16_f32 v196, v232, v233
    v_cvt_pk_bf16_f32 v197, v234, v235
    v_cvt_pk_bf16_f32 v198, v236, v237
    v_cvt_pk_bf16_f32 v199, v238, v239
    v_permlane16_swap_b32 v192, v194
    v_permlane16_swap_b32 v193, v195
    v_permlane16_swap_b32 v196, v198
    v_permlane16_swap_b32 v197, v199
    v_mov_b32 v176, v192
    v_mov_b32 v177, v193
    v_mov_b32 v178, v194
    v_mov_b32 v179, v195
    v_mov_b32_dpp v192, v196 row_ror:8 row_mask:0xf bank_mask:0xc
    v_mov_b32_dpp v193, v197 row_ror:8 row_mask:0xf bank_mask:0xc
    v_mov_b32_dpp v194, v198 row_ror:8 row_mask:0xf bank_mask:0xc
    v_mov_b32_dpp v195, v199 row_ror:8 row_mask:0xf bank_mask:0xc
    buffer_store_dwordx4 v[192:195], v47, s[36:39], 0 offen sc1
    v_mov_b32_dpp v196, v176 row_ror:8 row_mask:0xf bank_mask:0x3
    v_mov_b32_dpp v197, v177 row_ror:8 row_mask:0xf bank_mask:0x3
    v_mov_b32_dpp v198, v178 row_ror:8 row_mask:0xf bank_mask:0x3
    v_mov_b32_dpp v199, v179 row_ror:8 row_mask:0xf bank_mask:0x3
    buffer_store_dwordx4 v[196:199], v47, s[36:39], s79 offen sc1
L_end:
    s_endpgm
L_hot_end:
L_slow:
    s_waitcnt lgkmcnt(0)
    s_nop 15
    s_nop 3
    v_mov_b32 v200, 0x3f803f80
    v_mov_b32 v201, 0x3f803f80
    v_mov_b32 v202, 0x3f803f80
    v_mov_b32 v203, 0x3f803f80
    v_mov_b32 v204, 0x3f803f80
    v_mov_b32 v205, 0x3f803f80
    v_mov_b32 v206, 0x3f803f80
    v_mov_b32 v207, 0x3f803f80
    v_mov_b32 v192, 0x3f803f80
    v_mov_b32 v193, 0x3f803f80
    v_mov_b32 v194, 0x3f803f80
    v_mov_b32 v195, 0x3f803f80
    v_mov_b32 v196, 0x3f803f80
    v_mov_b32 v197, 0x3f803f80
    v_mov_b32 v198, 0x3f803f80
    v_mov_b32 v199, 0x3f803f80
    v_mov_b32 v1, 0xf149f2ca
    v_add_u32 v3, 32768, v5
    s_min_u32 s93, s84, 7
    ds_read_b128 v[52:55], v3 offset:0
    s_waitcnt lgkmcnt(0)
    v_mfma_f32_32x32x16_bf16 v[176:191], v[52:55], v[248:251], v[224:239]
    s_nop 15
    v_max3_f32 v1, v1, v176, v177
    v_max3_f32 v1, v1, v178, v179
    v_max3_f32 v1, v1, v180, v181
    v_max3_f32 v1, v1, v182, v183
    v_max3_f32 v1, v1, v184, v185
    v_max3_f32 v1, v1, v186, v187
    v_max3_f32 v1, v1, v188, v189
    v_max3_f32 v1, v1, v190, v191
    v_subrev_u32 v3, 4096, v3
L_sl_0_0_loop:
    s_cmp_eq_u32 s93, 0
    s_cbranch_scc1 L_sl_0_0_old
    ds_read_b128 v[52:55], v3 offset:0
    s_waitcnt lgkmcnt(0)
    v_mfma_f32_32x32x16_bf16 v[176:191], v[52:55], v[248:251], 0
    s_nop 15
    v_max3_f32 v1, v1, v176, v177
    v_max3_f32 v1, v1, v178, v179
    v_max3_f32 v1, v1, v180, v181
    v_max3_f32 v1, v1, v182, v183
    v_max3_f32 v1, v1, v184, v185
    v_max3_f32 v1, v1, v186, v187
    v_max3_f32 v1, v1, v188, v189
    v_max3_f32 v1, v1, v190, v191
    v_subrev_u32 v3, 4096, v3
    s_sub_u32 s93, s93, 1
    s_branch L_sl_0_0_loop
L_sl_0_0_old:
    s_cmp_lt_u32 s84, 8
    s_cbranch_scc1 L_sl_0_0_done
    ds_read_b128 v[52:55], v3 offset:0
    s_waitcnt lgkmcnt(0)
    v_mfma_f32_32x32x16_bf16 v[176:191], v[52:55], v[248:251], v[208:223]
    s_nop 15
    v_max3_f32 v1, v1, v176, v177
    v_max3_f32 v1, v1, v178, v179
    v_max3_f32 v1, v1, v180, v181
    v_max3_f32 v1, v1, v182, v183
    v_max3_f32 v1, v1, v184, v185
    v_max3_f32 v1, v1, v186, v187
    v_max3_f32 v1, v1, v188, v189
    v_max3_f32 v1, v1, v190, v191
    v_subrev_u32 v3, 4096, v3
L_sl_0_0_done:
    v_mov_b32 v2, v1
    s_nop 1
    v_permlane32_swap_b32 v1, v2
    s_nop 1
    v_max_f32 v1, v1, v2
    v_mov_b32 v144, 0
    v_mov_b32 v145, 0
    v_mov_b32 v146, 0
    v_mov_b32 v147, 0
    v_mov_b32 v148, 0
    v_mov_b32 v149, 0
    v_mov_b32 v150, 0
    v_mov_b32 v151, 0
    v_mov_b32 v152, 0
    v_mov_b32 v153, 0
    v_mov_b32 v154, 0
    v_mov_b32 v155, 0
    v_mov_b32 v156, 0
    v_mov_b32 v157, 0
    v_mov_b32 v158, 0
    v_mov_b32 v159, 0
    v_add_u32 v3, 32768, v5
    s_min_u32 s93, s84, 7
    ds_read_b128 v[52:55], v3 offset:0
    s_mov_b64 exec, s[86:87]
    ds_read_b128 v[200:203], v3 offset:2048
    ds_read_b128 v[204:207], v3 offset:3072
    s_mov_b64 exec, -1
    s_waitcnt lgkmcnt(0)
    v_mfma_f32_32x32x16_bf16 v[176:191], v[52:55], v[248:251], v[224:239]
    s_nop 15
    v_sub_f32 v176, v176, v1
    v_sub_f32 v177, v177, v1
    v_sub_f32 v178, v178, v1
    v_sub_f32 v179, v179, v1
    v_sub_f32 v180, v180, v1
    v_sub_f32 v181, v181, v1
    v_sub_f32 v182, v182, v1
    v_sub_f32 v183, v183, v1
    v_sub_f32 v184, v184, v1
    v_sub_f32 v185, v185, v1
    v_sub_f32 v186, v186, v1
    v_sub_f32 v187, v187, v1
    v_sub_f32 v188, v188, v1
    v_sub_f32 v189, v189, v1
    v_sub_f32 v190, v190, v1
    v_sub_f32 v191, v191, v1
    v_exp_f32 v176, v176
    v_exp_f32 v177, v177
    v_exp_f32 v178, v178
    v_exp_f32 v179, v179
    v_exp_f32 v180, v180
    v_exp_f32 v181, v181
    v_exp_f32 v182, v182
    v_exp_f32 v183, v183
    v_exp_f32 v184, v184
    v_exp_f32 v185, v185
    v_exp_f32 v186, v186
    v_exp_f32 v187, v187
    v_exp_f32 v188, v188
    v_exp_f32 v189, v189
    v_exp_f32 v190, v190
    v_exp_f32 v191, v191
    s_nop 0
    v_cvt_pk_bf16_f32 v240, v176, v177
    v_cvt_pk_bf16_f32 v241, v178, v179
    v_cvt_pk_bf16_f32 v242, v180, v181
    v_cvt_pk_bf16_f32 v243, v182, v183
    v_cvt_pk_bf16_f32 v244, v184, v185
    v_cvt_pk_bf16_f32 v245, v186, v187
    v_cvt_pk_bf16_f32 v246, v188, v189
    v_cvt_pk_bf16_f32 v247, v190, v191
    s_nop 1
    v_mfma_f32_32x32x16_bf16 v[144:159], v[200:203], v[240:243], v[144:159]
    v_mfma_f32_32x32x16_bf16 v[144:159], v[204:207], v[244:247], v[144:159]
    s_nop 15
    v_subrev_u32 v3, 4096, v3
L_sl_0_1_loop:
    s_cmp_eq_u32 s93, 0
    s_cbranch_scc1 L_sl_0_1_old
    ds_read_b128 v[52:55], v3 offset:0
    s_mov_b64 exec, s[86:87]
    ds_read_b128 v[200:203], v3 offset:2048
    ds_read_b128 v[204:207], v3 offset:3072
    s_mov_b64 exec, -1
    s_waitcnt lgkmcnt(0)
    v_mfma_f32_32x32x16_bf16 v[176:191], v[52:55], v[248:251], 0
    s_nop 15
    v_sub_f32 v176, v176, v1
    v_sub_f32 v177, v177, v1
    v_sub_f32 v178, v178, v1
    v_sub_f32 v179, v179, v1
    v_sub_f32 v180, v180, v1
    v_sub_f32 v181, v181, v1
    v_sub_f32 v182, v182, v1
    v_sub_f32 v183, v183, v1
    v_sub_f32 v184, v184, v1
    v_sub_f32 v185, v185, v1
    v_sub_f32 v186, v186, v1
    v_sub_f32 v187, v187, v1
    v_sub_f32 v188, v188, v1
    v_sub_f32 v189, v189, v1
    v_sub_f32 v190, v190, v1
    v_sub_f32 v191, v191, v1
    v_exp_f32 v176, v176
    v_exp_f32 v177, v177
    v_exp_f32 v178, v178
    v_exp_f32 v179, v179
    v_exp_f32 v180, v180
    v_exp_f32 v181, v181
    v_exp_f32 v182, v182
    v_exp_f32 v183, v183
    v_exp_f32 v184, v184
    v_exp_f32 v185, v185
    v_exp_f32 v186, v186
    v_exp_f32 v187, v187
    v_exp_f32 v188, v188
    v_exp_f32 v189, v189
    v_exp_f32 v190, v190
    v_exp_f32 v191, v191
    s_nop 0
    v_cvt_pk_bf16_f32 v240, v176, v177
    v_cvt_pk_bf16_f32 v241, v178, v179
    v_cvt_pk_bf16_f32 v242, v180, v181
    v_cvt_pk_bf16_f32 v243, v182, v183
    v_cvt_pk_bf16_f32 v244, v184, v185
    v_cvt_pk_bf16_f32 v245, v186, v187
    v_cvt_pk_bf16_f32 v246, v188, v189
    v_cvt_pk_bf16_f32 v247, v190, v191
    s_nop 1
    v_mfma_f32_32x32x16_bf16 v[144:159], v[200:203], v[240:243], v[144:159]
    v_mfma_f32_32x32x16_bf16 v[144:159], v[204:207], v[244:247], v[144:159]
    s_nop 15
    v_subrev_u32 v3, 4096, v3
    s_sub_u32 s93, s93, 1
    s_branch L_sl_0_1_loop
L_sl_0_1_old:
    s_cmp_lt_u32 s84, 8
    s_cbranch_scc1 L_sl_0_1_done
    ds_read_b128 v[52:55], v3 offset:0
    s_mov_b64 exec, s[86:87]
    ds_read_b128 v[200:203], v3 offset:2048
    ds_read_b128 v[204:207], v3 offset:3072
    s_mov_b64 exec, -1
    s_waitcnt lgkmcnt(0)
    v_mfma_f32_32x32x16_bf16 v[176:191], v[52:55], v[248:251], v[208:223]
    s_nop 15
    v_sub_f32 v176, v176, v1
    v_sub_f32 v177, v177, v1
    v_sub_f32 v178, v178, v1
    v_sub_f32 v179, v179, v1
    v_sub_f32 v180, v180, v1
    v_sub_f32 v181, v181, v1
    v_sub_f32 v182, v182, v1
    v_sub_f32 v183, v183, v1
    v_sub_f32 v184, v184, v1
    v_sub_f32 v185, v185, v1
    v_sub_f32 v186, v186, v1
    v_sub_f32 v187, v187, v1
    v_sub_f32 v188, v188, v1
    v_sub_f32 v189, v189, v1
    v_sub_f32 v190, v190, v1
    v_sub_f32 v191, v191, v1
    v_exp_f32 v176, v176
    v_exp_f32 v177, v177
    v_exp_f32 v178, v178
    v_exp_f32 v179, v179
    v_exp_f32 v180, v180
    v_exp_f32 v181, v181
    v_exp_f32 v182, v182
    v_exp_f32 v183, v183
    v_exp_f32 v184, v184
    v_exp_f32 v185, v185
    v_exp_f32 v186, v186
    v_exp_f32 v187, v187
    v_exp_f32 v188, v188
    v_exp_f32 v189, v189
    v_exp_f32 v190, v190
    v_exp_f32 v191, v191
    s_nop 0
    v_cvt_pk_bf16_f32 v240, v176, v177
    v_cvt_pk_bf16_f32 v241, v178, v179
    v_cvt_pk_bf16_f32 v242, v180, v181
    v_cvt_pk_bf16_f32 v243, v182, v183
    v_cvt_pk_bf16_f32 v244, v184, v185
    v_cvt_pk_bf16_f32 v245, v186, v187
    v_cvt_pk_bf16_f32 v246, v188, v189
    v_cvt_pk_bf16_f32 v247, v190, v191
    s_nop 1
    v_mfma_f32_32x32x16_bf16 v[144:159], v[200:203], v[240:243], v[144:159]
    v_mfma_f32_32x32x16_bf16 v[144:159], v[204:207], v[244:247], v[144:159]
    s_nop 15
    v_subrev_u32 v3, 4096, v3
L_sl_0_1_done:
    v_mov_b32 v1, 0xf149f2ca
    v_add_u32 v3, 32768, v5
    s_min_u32 s93, s84, 7
    ds_read_b128 v[52:55], v3 offset:1024
    s_waitcnt lgkmcnt(0)
    v_mfma_f32_32x32x16_bf16 v[176:191], v[52:55], v[252:255], v[224:239]
    s_nop 15
    v_max3_f32 v1, v1, v176, v177
    v_max3_f32 v1, v1, v178, v179
    v_max3_f32 v1, v1, v180, v181
    v_max3_f32 v1, v1, v182, v183
    v_max3_f32 v1, v1, v184, v185
    v_max3_f32 v1, v1, v186, v187
    v_max3_f32 v1, v1, v188, v189
    v_max3_f32 v1, v1, v190, v191
    v_subrev_u32 v3, 4096, v3
L_sl_1_0_loop:
    s_cmp_eq_u32 s93, 0
    s_cbranch_scc1 L_sl_1_0_old
    ds_read_b128 v[52:55], v3 offset:1024
    s_waitcnt lgkmcnt(0)
    v_mfma_f32_32x32x16_bf16 v[176:191], v[52:55], v[252:255], 0
    s_nop 15
    v_max3_f32 v1, v1, v176, v177
    v_max3_f32 v1, v1, v178, v179
    v_max3_f32 v1, v1, v180, v181
    v_max3_f32 v1, v1, v182, v183
    v_max3_f32 v1, v1, v184, v185
    v_max3_f32 v1, v1, v186, v187
    v_max3_f32 v1, v1, v188, v189
    v_max3_f32 v1, v1, v190, v191
    v_subrev_u32 v3, 4096, v3
    s_sub_u32 s93, s93, 1
    s_branch L_sl_1_0_loop
L_sl_1_0_old:
    s_cmp_lt_u32 s84, 8
    s_cbranch_scc1 L_sl_1_0_done
    ds_read_b128 v[52:55], v3 offset:1024
    s_waitcnt lgkmcnt(0)
    v_mfma_f32_32x32x16_bf16 v[176:191], v[52:55], v[252:255], v[208:223]
    s_nop 15
    v_max3_f32 v1, v1, v176, v177
    v_max3_f32 v1, v1, v178, v179
    v_max3_f32 v1, v1, v180, v181
    v_max3_f32 v1, v1, v182, v183
    v_max3_f32 v1, v1, v184, v185
    v_max3_f32 v1, v1, v186, v187
    v_max3_f32 v1, v1, v188, v189
    v_max3_f32 v1, v1, v190, v191
    v_subrev_u32 v3, 4096, v3
L_sl_1_0_done:
    v_mov_b32 v2, v1
    s_nop 1
    v_permlane32_swap_b32 v1, v2
    s_nop 1
    v_max_f32 v1, v1, v2
    v_mov_b32 v128, 0
    v_mov_b32 v129, 0
    v_mov_b32 v130, 0
    v_mov_b32 v131, 0
    v_mov_b32 v132, 0
    v_mov_b32 v133, 0
    v_mov_b32 v134, 0
    v_mov_b32 v135, 0
    v_mov_b32 v136, 0
    v_mov_b32 v137, 0
    v_mov_b32 v138, 0
    v_mov_b32 v139, 0
    v_mov_b32 v140, 0
    v_mov_b32 v141, 0
    v_mov_b32 v142, 0
    v_mov_b32 v143, 0
    v_add_u32 v3, 32768, v5
    s_min_u32 s93, s84, 7
    ds_read_b128 v[52:55], v3 offset:1024
    s_mov_b64 exec, s[88:89]
    ds_read_b128 v[192:195], v3 offset:2048
    ds_read_b128 v[196:199], v3 offset:3072
    s_mov_b64 exec, -1
    s_waitcnt lgkmcnt(0)
    v_mfma_f32_32x32x16_bf16 v[176:191], v[52:55], v[252:255], v[224:239]
    s_nop 15
    v_sub_f32 v176, v176, v1
    v_sub_f32 v177, v177, v1
    v_sub_f32 v178, v178, v1
    v_sub_f32 v179, v179, v1
    v_sub_f32 v180, v180, v1
    v_sub_f32 v181, v181, v1
    v_sub_f32 v182, v182, v1
    v_sub_f32 v183, v183, v1
    v_sub_f32 v184, v184, v1
    v_sub_f32 v185, v185, v1
    v_sub_f32 v186, v186, v1
    v_sub_f32 v187, v187, v1
    v_sub_f32 v188, v188, v1
    v_sub_f32 v189, v189, v1
    v_sub_f32 v190, v190, v1
    v_sub_f32 v191, v191, v1
    v_exp_f32 v176, v176
    v_exp_f32 v177, v177
    v_exp_f32 v178, v178
    v_exp_f32 v179, v179
    v_exp_f32 v180, v180
    v_exp_f32 v181, v181
    v_exp_f32 v182, v182
    v_exp_f32 v183, v183
    v_exp_f32 v184, v184
    v_exp_f32 v185, v185
    v_exp_f32 v186, v186
    v_exp_f32 v187, v187
    v_exp_f32 v188, v188
    v_exp_f32 v189, v189
    v_exp_f32 v190, v190
    v_exp_f32 v191, v191
    s_nop 0
    v_cvt_pk_bf16_f32 v240, v176, v177
    v_cvt_pk_bf16_f32 v241, v178, v179
    v_cvt_pk_bf16_f32 v242, v180, v181
    v_cvt_pk_bf16_f32 v243, v182, v183
    v_cvt_pk_bf16_f32 v244, v184, v185
    v_cvt_pk_bf16_f32 v245, v186, v187
    v_cvt_pk_bf16_f32 v246, v188, v189
    v_cvt_pk_bf16_f32 v247, v190, v191
    s_nop 1
    v_mfma_f32_32x32x16_bf16 v[128:143], v[192:195], v[240:243], v[128:143]
    v_mfma_f32_32x32x16_bf16 v[128:143], v[196:199], v[244:247], v[128:143]
    s_nop 15
    v_subrev_u32 v3, 4096, v3
L_sl_1_1_loop:
    s_cmp_eq_u32 s93, 0
    s_cbranch_scc1 L_sl_1_1_old
    ds_read_b128 v[52:55], v3 offset:1024
    s_mov_b64 exec, s[88:89]
    ds_read_b128 v[192:195], v3 offset:2048
    ds_read_b128 v[196:199], v3 offset:3072
    s_mov_b64 exec, -1
    s_waitcnt lgkmcnt(0)
    v_mfma_f32_32x32x16_bf16 v[176:191], v[52:55], v[252:255], 0
    s_nop 15
    v_sub_f32 v176, v176, v1
    v_sub_f32 v177, v177, v1
    v_sub_f32 v178, v178, v1
    v_sub_f32 v179, v179, v1
    v_sub_f32 v180, v180, v1
    v_sub_f32 v181, v181, v1
    v_sub_f32 v182, v182, v1
    v_sub_f32 v183, v183, v1
    v_sub_f32 v184, v184, v1
    v_sub_f32 v185, v185, v1
    v_sub_f32 v186, v186, v1
    v_sub_f32 v187, v187, v1
    v_sub_f32 v188, v188, v1
    v_sub_f32 v189, v189, v1
    v_sub_f32 v190, v190, v1
    v_sub_f32 v191, v191, v1
    v_exp_f32 v176, v176
    v_exp_f32 v177, v177
    v_exp_f32 v178, v178
    v_exp_f32 v179, v179
    v_exp_f32 v180, v180
    v_exp_f32 v181, v181
    v_exp_f32 v182, v182
    v_exp_f32 v183, v183
    v_exp_f32 v184, v184
    v_exp_f32 v185, v185
    v_exp_f32 v186, v186
    v_exp_f32 v187, v187
    v_exp_f32 v188, v188
    v_exp_f32 v189, v189
    v_exp_f32 v190, v190
    v_exp_f32 v191, v191
    s_nop 0
    v_cvt_pk_bf16_f32 v240, v176, v177
    v_cvt_pk_bf16_f32 v241, v178, v179
    v_cvt_pk_bf16_f32 v242, v180, v181
    v_cvt_pk_bf16_f32 v243, v182, v183
    v_cvt_pk_bf16_f32 v244, v184, v185
    v_cvt_pk_bf16_f32 v245, v186, v187
    v_cvt_pk_bf16_f32 v246, v188, v189
    v_cvt_pk_bf16_f32 v247, v190, v191
    s_nop 1
    v_mfma_f32_32x32x16_bf16 v[128:143], v[192:195], v[240:243], v[128:143]
    v_mfma_f32_32x32x16_bf16 v[128:143], v[196:199], v[244:247], v[128:143]
    s_nop 15
    v_subrev_u32 v3, 4096, v3
    s_sub_u32 s93, s93, 1
    s_branch L_sl_1_1_loop
L_sl_1_1_old:
    s_cmp_lt_u32 s84, 8
    s_cbranch_scc1 L_sl_1_1_done
    ds_read_b128 v[52:55], v3 offset:1024
    s_mov_b64 exec, s[88:89]
    ds_read_b128 v[192:195], v3 offset:2048
    ds_read_b128 v[196:199], v3 offset:3072
    s_mov_b64 exec, -1
    s_waitcnt lgkmcnt(0)
    v_mfma_f32_32x32x16_bf16 v[176:191], v[52:55], v[252:255], v[208:223]
    s_nop 15
    v_sub_f32 v176, v176, v1
    v_sub_f32 v177, v177, v1
    v_sub_f32 v178, v178, v1
    v_sub_f32 v179, v179, v1
    v_sub_f32 v180, v180, v1
    v_sub_f32 v181, v181, v1
    v_sub_f32 v182, v182, v1
    v_sub_f32 v183, v183, v1
    v_sub_f32 v184, v184, v1
    v_sub_f32 v185, v185, v1
    v_sub_f32 v186, v186, v1
    v_sub_f32 v187, v187, v1
    v_sub_f32 v188, v188, v1
    v_sub_f32 v189, v189, v1
    v_sub_f32 v190, v190, v1
    v_sub_f32 v191, v191, v1
    v_exp_f32 v176, v176
    v_exp_f32 v177, v177
    v_exp_f32 v178, v178
    v_exp_f32 v179, v179
    v_exp_f32 v180, v180
    v_exp_f32 v181, v181
    v_exp_f32 v182, v182
    v_exp_f32 v183, v183
    v_exp_f32 v184, v184
    v_exp_f32 v185, v185
    v_exp_f32 v186, v186
    v_exp_f32 v187, v187
    v_exp_f32 v188, v188
    v_exp_f32 v189, v189
    v_exp_f32 v190, v190
    v_exp_f32 v191, v191
    s_nop 0
    v_cvt_pk_bf16_f32 v240, v176, v177
    v_cvt_pk_bf16_f32 v241, v178, v179
    v_cvt_pk_bf16_f32 v242, v180, v181
    v_cvt_pk_bf16_f32 v243, v182, v183
    v_cvt_pk_bf16_f32 v244, v184, v185
    v_cvt_pk_bf16_f32 v245, v186, v187
    v_cvt_pk_bf16_f32 v246, v188, v189
    v_cvt_pk_bf16_f32 v247, v190, v191
    s_nop 1
    v_mfma_f32_32x32x16_bf16 v[128:143], v[192:195], v[240:243], v[128:143]
    v_mfma_f32_32x32x16_bf16 v[128:143], v[196:199], v[244:247], v[128:143]
    s_nop 15
    v_subrev_u32 v3, 4096, v3
L_sl_1_1_done:
    s_nop 15
    s_branch L_slow_back
.section .rodata,"a"
.p2align 6
.amdhsa_kernel gated_mix__sliding_block__glu_gated_glu__prompt_kernel
  .amdhsa_next_free_vgpr 512
  .amdhsa_next_free_sgpr 102
  .amdhsa_accum_offset 256
  .amdhsa_group_segment_fixed_size 0
  .amdhsa_kernarg_size 88
  .amdhsa_user_sgpr_count 2
  .amdhsa_user_sgpr_kernarg_segment_ptr 1
  .amdhsa_system_sgpr_workgroup_id_x 1
  .amdhsa_float_denorm_mode_32 3
.end_amdhsa_kernel
```
